```python
import torch

def _softmax(x, axis=-1):
    return torch.softmax(x, dim=axis)

def _gelu(x):
    return torch.nn.functional.gelu(x, approximate='tanh')

def _silu(x):
    return torch.nn.functional.silu(x)

def _sigmoid(x):
    return torch.sigmoid(x)

def _layernorm(x, axis=-1, eps=1e-05):
    m = x.mean(dim=axis, keepdim=True)
    v = x.var(dim=axis, keepdim=True, unbiased=False)
    return (x - m) / torch.sqrt(v + eps)

def _scatter_add(tgt, idx, src, axis=0):
    return tgt.clone().index_add_(axis, idx, src)

def _segment_sum(src, seg, n):
    out = torch.zeros((n,) + src.shape[1:], dtype=src.dtype)
    return out.index_add_(0, seg, src)

def _pad(x, pw):
    flat = tuple((v for pair in reversed(pw) for v in pair))
    return torch.nn.functional.pad(x, flat)
kernel_name = 'adaLN_cond__mha_block_cached__geglu_ffn__decode'

def setup_inputs():

    _w = lambda a: (lambda t: t.to(torch.bfloat16) if t.is_floating_point() else t)(torch.as_tensor(a))

    def _A_setup():
        B, Sq, D = (2, 1, 576)
        H, Sk, Dh = (32, 4096, 128)
        return {'x': _w((lambda *s: torch.randn(*s, dtype=torch.bfloat16) * 0.1)(B, Sq, D)), 'k_cache': _w((lambda *s: torch.randn(*s, dtype=torch.bfloat16) * 0.8)(B, H, Sk, Dh)), 'v_cache': _w((lambda *s: torch.randn(*s, dtype=torch.bfloat16) * 0.8)(B, H, Sk, Dh)), 'wq': _w((lambda *s: torch.randn(*s, dtype=torch.bfloat16) * 0.8)(D, H * Dh) * D ** (-0.5)), 'wo': _w((lambda *s: torch.randn(*s, dtype=torch.bfloat16) * 0.8)(H * Dh, D) * (H * Dh) ** (-0.5))}
    _A_in = _A_setup()

    def _B_setup():
        B, S, D, F = (2, 1, 576, 4608)
        return {'x': _w((lambda *s: torch.randn(*s, dtype=torch.bfloat16) * 0.1)(B, S, D)), 'w_gate': _w((lambda *s: torch.randn(*s, dtype=torch.bfloat16) * 0.1)(D, F)), 'w_up': _w((lambda *s: torch.randn(*s, dtype=torch.bfloat16) * 0.1)(D, F)), 'w_down': _w((lambda *s: torch.randn(*s, dtype=torch.bfloat16) * 0.1)(F, D))}
    _B_in = _B_setup()
    return {'A_x': _A_in['x'], 'A_k_cache': _A_in['k_cache'], 'A_v_cache': _A_in['v_cache'], 'A_wq': _A_in['wq'], 'A_wo': _A_in['wo'], 'B_x': _B_in['x'], 'B_w_gate': _B_in['w_gate'], 'B_w_up': _B_in['w_up'], 'B_w_down': _B_in['w_down'], 'c': _w((lambda *s: torch.randn(*s, dtype=torch.bfloat16) * 0.4)(2, 576) * 8.0), 'w_mod': _w((lambda *s: torch.randn(*s, dtype=torch.bfloat16) * 0.4)(576, 6 * 576) * 576 ** (-0.5) * 8.0)}

def reference(A_x, A_k_cache, A_v_cache, A_wq, A_wo, B_x, B_w_gate, B_w_up, B_w_down, c, w_mod):

    def _A_ref(x, k_cache, v_cache, wq, wo):
        B, Sq, D = x.shape
        H, Dh = (32, 128)
        q = (lambda x, *d: x.permute(*d))((x @ wq).reshape(B, Sq, H, Dh), 0, 2, 1, 3)
        scores = torch.einsum('bhqd,bhkd->bhqk', q, k_cache) * Dh ** (-0.5)
        p = _softmax(scores, axis=-1)
        o = torch.einsum('bhqk,bhkd->bhqd', p, v_cache)
        return (lambda x, *d: x.permute(*d))(o, 0, 2, 1, 3).reshape(B, Sq, H * Dh) @ wo

    def _B_ref(x, w_gate, w_up, w_down):
        return _gelu(x @ w_gate) * (x @ w_up) @ w_down
    x = A_x
    mod = (_silu(c) @ w_mod).reshape(c.shape[0], 6, 1, -1)
    sa, ca, ga, sb, cb, gb = (mod[:, 0].clone(), mod[:, 1].clone(), mod[:, 2].clone(), mod[:, 3].clone(), mod[:, 4].clone(), mod[:, 5].clone())
    h = _layernorm(x, axis=-1) * (1 + ca) + sa
    x = x + ga * _A_ref(h, A_k_cache, A_v_cache, A_wq, A_wo)
    h = _layernorm(x, axis=-1) * (1 + cb) + sb
    x = x + gb * _B_ref(h, B_w_gate, B_w_up, B_w_down)
    return x
```

```asm
; @launch grid=(256,1,1) block=(1024,1,1) lds=86016
.amdgcn_target "amdgcn-amd-amdhsa--gfx950"
.text
.globl adaLN_cond__mha_block_cached__geglu_ffn__decode_kernel
.p2align 8
.type adaLN_cond__mha_block_cached__geglu_ffn__decode_kernel,@function
adaLN_cond__mha_block_cached__geglu_ffn__decode_kernel:
    s_cmp_ge_u32 s2, 256
    s_cbranch_scc1 Lend
    s_load_dwordx16 s[16:31], s[0:1], 0
    s_load_dwordx8 s[32:39], s[0:1], 64
    s_load_dwordx4 s[40:43], s[0:1], 96
    v_lshrrev_b32 v2, 6, v0
    v_and_b32 v1, 63, v0
    v_mov_b32 v5, 0
    v_readfirstlane_b32 s4, v2
    s_and_b32 s9, s2, 7
    s_lshr_b32 s8, s2, 3
    s_lshl_b32 s3, s9, 5
    s_or_b32 s3, s3, s8
    s_lshr_b32 s5, s3, 3
    s_bfe_u32 s6, s3, 0x10002
    s_and_b32 s7, s3, 3
    s_mov_b32 s70, 0x100000
    v_and_b32 v2, 15, v1
    v_lshrrev_b32 v3, 4, v1
    s_bitcmp1_b32 s9, 0
    s_cselect_b32 s12, 1393984544, s70
    s_cselect_b32 s13, 7, 8
    s_cbranch_scc1 Lfm
    s_mov_b32 s12, 1679848753
Lfm:
    s_cmp_eq_u32 s9, 5
    s_cselect_b32 s12, 1393853984, s12
    s_and_b32 s10, s8, 1
    s_mul_i32 s10, s10, 9
    s_lshr_b32 s11, s8, 1
    s_add_u32 s10, s10, s11
    s_lshr_b32 s11, s10, 1
    s_lshl_b32 s11, s11, 2
    s_lshr_b64 s[12:13], s[12:13], s11
    s_and_b32 s12, s12, 15
    s_mul_i32 s11, s9, 9
    s_add_u32 s12, s12, s11
    s_and_b32 s10, s10, 1
    s_lshl1_add_u32 s10, s12, s10
    v_and_b32 v4, 7, v1
    v_and_b32 v6, 1, v1
    v_lshlrev_b32 v6, 4, v6
    v_mov_b32 v7, 0xffff
    v_lshlrev_b32 v6, v6, v7
    v_lshrrev_b32 v4, 1, v4
    v_cmp_eq_u32 vcc, 0, v4
    s_nop 1
    v_cndmask_b32 v12, 0, v6, vcc
    v_cmp_eq_u32 vcc, 1, v4
    s_nop 1
    v_cndmask_b32 v13, 0, v6, vcc
    v_cmp_eq_u32 vcc, 2, v4
    s_nop 1
    v_cndmask_b32 v14, 0, v6, vcc
    v_cmp_eq_u32 vcc, 3, v4
    s_nop 1
    v_cndmask_b32 v15, 0, v6, vcc
    s_waitcnt lgkmcnt(0)
    s_add_u32 s12, s42, 2068480
    s_addc_u32 s13, s43, 0
    s_load_dword s97, s[12:13], 0
    s_movk_i32 s96, 0x3ff
    s_mov_b32 s98, 0xfffffc00
    s_mov_b32 s44, s42
    s_and_b32 s45, s43, 0xffff
    s_mov_b32 s46, 4194304
    s_mov_b32 s47, 0x20000
    s_cmp_lt_u32 s4, 8
    s_cbranch_scc1 Lhelper
    s_sub_u32 s4, s4, 8
    s_mov_b32 s48, s18
    s_and_b32 s49, s19, 0xffff
    s_mov_b32 s50, 67108864
    s_mov_b32 s51, 0x20000
    s_mov_b32 s52, s20
    s_and_b32 s53, s21, 0xffff
    s_mov_b32 s54, 67108864
    s_mov_b32 s55, 0x20000
    s_lshl_b32 s11, s6, 5
    s_add_u32 s11, s11, s5
    s_lshl_b32 s11, s11, 20
    s_lshl_b32 s12, s4, 15
    s_add_u32 s11, s11, s12
    s_lshl_b32 s12, s7, 18
    s_add_u32 s12, s12, s11
    s_xor_b32 s13, s7, 1
    s_lshl_b32 s13, s13, 18
    s_add_u32 s13, s13, s11
    v_lshl_add_u32 v6, v1, 4, s12
    v_bfe_u32 v4, v1, 3, 1
    v_lshl_add_u32 v4, v4, 2, v3
    v_lshlrev_b32 v4, 8, v4
    v_and_b32 v7, 7, v1
    v_lshl_add_u32 v4, v7, 4, v4
    s_and_b32 s14, s7, 1
    s_lshl_b32 s14, s14, 7
    v_add_u32 v4, s14, v4
    v_add_u32 v7, s12, v4
    v_add_u32 v30, s13, v4
    s_min_u32 s14, s12, s13
    s_max_u32 s13, s12, s13
    v_add_u32 v7, s14, v4
    v_add_u32 v30, s13, v4
    s_mov_b32 s64, 0xcccccccc
    s_mov_b32 s65, 0xcccccccc
    s_mov_b32 s66, 0xaaaaaaaa
    s_mov_b32 s67, 0xaaaaaaaa
    s_movk_i32 s15, 0
    buffer_load_dwordx4 v[124:127], v6, s[48:51], s15 offen nt
    s_movk_i32 s15, 1024
    buffer_load_dwordx4 v[120:123], v6, s[48:51], s15 offen nt
    s_movk_i32 s15, 2048
    buffer_load_dwordx4 v[116:119], v6, s[48:51], s15 offen nt
    s_barrier
    s_waitcnt vmcnt(2)
    s_movk_i32 s15, 3072
    buffer_load_dwordx4 v[112:115], v6, s[48:51], s15 offen nt
    s_waitcnt vmcnt(2)
    s_movk_i32 s15, 4096
    buffer_load_dwordx4 v[108:111], v6, s[48:51], s15 offen nt
    s_waitcnt vmcnt(2)
    s_movk_i32 s15, 5120
    buffer_load_dwordx4 v[104:107], v6, s[48:51], s15 offen nt
    s_waitcnt vmcnt(2)
    s_movk_i32 s15, 6144
    buffer_load_dwordx4 v[100:103], v6, s[48:51], s15 offen nt
    s_waitcnt vmcnt(2)
    s_movk_i32 s15, 7168
    buffer_load_dwordx4 v[96:99], v6, s[48:51], s15 offen nt
    s_waitcnt vmcnt(2)
    s_movk_i32 s15, 8192
    buffer_load_dwordx4 v[92:95], v6, s[48:51], s15 offen nt
    s_waitcnt vmcnt(2)
    s_movk_i32 s15, 9216
    buffer_load_dwordx4 v[88:91], v6, s[48:51], s15 offen nt
    s_waitcnt vmcnt(2)
    s_movk_i32 s15, 10240
    buffer_load_dwordx4 v[84:87], v6, s[48:51], s15 offen nt
    s_waitcnt vmcnt(2)
    s_movk_i32 s15, 11264
    buffer_load_dwordx4 v[80:83], v6, s[48:51], s15 offen nt
    s_waitcnt vmcnt(2)
    s_movk_i32 s15, 12288
    buffer_load_dwordx4 v[76:79], v6, s[48:51], s15 offen nt
    s_waitcnt vmcnt(2)
    s_movk_i32 s15, 13312
    buffer_load_dwordx4 v[72:75], v6, s[48:51], s15 offen nt
    s_waitcnt vmcnt(2)
    s_movk_i32 s15, 14336
    buffer_load_dwordx4 v[68:71], v6, s[48:51], s15 offen nt
    s_waitcnt vmcnt(2)
    s_movk_i32 s15, 15360
    buffer_load_dwordx4 v[64:67], v6, s[48:51], s15 offen nt
    s_waitcnt vmcnt(2)
    s_movk_i32 s15, 16384
    buffer_load_dwordx4 v[60:63], v6, s[48:51], s15 offen nt
    s_waitcnt vmcnt(2)
    s_movk_i32 s15, 17408
    buffer_load_dwordx4 v[56:59], v6, s[48:51], s15 offen nt
    s_waitcnt vmcnt(2)
    s_movk_i32 s15, 18432
    buffer_load_dwordx4 v[52:55], v6, s[48:51], s15 offen nt
    s_waitcnt vmcnt(2)
    s_movk_i32 s15, 19456
    buffer_load_dwordx4 v[48:51], v6, s[48:51], s15 offen nt
    s_waitcnt vmcnt(2)
    s_movk_i32 s15, 20480
    buffer_load_dwordx4 v[44:47], v6, s[48:51], s15 offen nt
    s_waitcnt vmcnt(2)
    s_movk_i32 s15, 21504
    buffer_load_dwordx4 v[40:43], v6, s[48:51], s15 offen nt
    s_waitcnt vmcnt(2)
    s_movk_i32 s15, 22528
    buffer_load_dwordx4 v[36:39], v6, s[48:51], s15 offen nt
    s_waitcnt vmcnt(2)
    s_movk_i32 s15, 23552
    buffer_load_dwordx4 v[32:35], v6, s[48:51], s15 offen nt
    s_waitcnt vmcnt(2)
    s_waitcnt lgkmcnt(0)
    s_add_u32 s97, s97, 1
    s_and_b32 s99, s97, s96
    v_mov_b32 v0, s99
Lsp_1:
    ds_read_b32 v4, v5 offset:7488
    s_waitcnt lgkmcnt(0)
    v_readfirstlane_b32 s11, v4
    s_cmp_lg_u32 s11, 0
    s_cbranch_scc1 Lspd_2
    s_sleep 1
    s_sub_u32 s70, s70, 1
    s_cmp_gt_i32 s70, 0
    s_cbranch_scc1 Lsp_1
Lspd_2:
    v_lshlrev_b32 v4, 4, v2
    ds_read_b128 v[8:11], v4 offset:7040
    s_waitcnt lgkmcnt(0)
    s_and_b32 s63, s7, 1
    s_mul_i32 s63, s63, 0
    s_add_u32 s63, s63, 4
    s_and_b32 s11, s10, 14
    s_cmp_eq_u32 s11, 6
    s_cselect_b32 s11, 4, 4
    s_cmp_lt_u32 s8, 18
    s_cselect_b32 s11, s11, 0
    s_add_u32 s63, s63, s11
    v_dot2_f32_bf16 v20, v124, v8, 0
    v_dot2_f32_bf16 v21, v120, v8, 0
    v_dot2_f32_bf16 v20, v125, v9, v20
    v_dot2_f32_bf16 v21, v121, v9, v21
    v_dot2_f32_bf16 v20, v126, v10, v20
    v_dot2_f32_bf16 v21, v122, v10, v21
    v_dot2_f32_bf16 v20, v127, v11, v20
    v_dot2_f32_bf16 v21, v123, v11, v21
    s_nop 1
    v_add_f32_dpp v22, v20, v20 row_ror:8 row_mask:0xf bank_mask:0x3
    s_nop 1
    v_add_f32_dpp v22, v21, v21 row_ror:8 row_mask:0xf bank_mask:0xc
    v_dot2_f32_bf16 v20, v116, v8, 0
    v_dot2_f32_bf16 v21, v112, v8, 0
    v_dot2_f32_bf16 v20, v117, v9, v20
    v_dot2_f32_bf16 v21, v113, v9, v21
    v_dot2_f32_bf16 v20, v118, v10, v20
    v_dot2_f32_bf16 v21, v114, v10, v21
    v_dot2_f32_bf16 v20, v119, v11, v20
    v_dot2_f32_bf16 v21, v115, v11, v21
    s_nop 1
    v_add_f32_dpp v23, v20, v20 row_ror:8 row_mask:0xf bank_mask:0x3
    s_nop 1
    v_add_f32_dpp v23, v21, v21 row_ror:8 row_mask:0xf bank_mask:0xc
    v_add_f32_dpp v24, v22, v22 row_half_mirror row_mask:0xf bank_mask:0x5
    s_nop 1
    v_add_f32_dpp v24, v23, v23 row_half_mirror row_mask:0xf bank_mask:0xa
    v_dot2_f32_bf16 v20, v108, v8, 0
    v_dot2_f32_bf16 v21, v104, v8, 0
    v_dot2_f32_bf16 v20, v109, v9, v20
    v_dot2_f32_bf16 v21, v105, v9, v21
    v_dot2_f32_bf16 v20, v110, v10, v20
    v_dot2_f32_bf16 v21, v106, v10, v21
    v_dot2_f32_bf16 v20, v111, v11, v20
    v_dot2_f32_bf16 v21, v107, v11, v21
    s_nop 1
    v_add_f32_dpp v22, v20, v20 row_ror:8 row_mask:0xf bank_mask:0x3
    s_nop 1
    v_add_f32_dpp v22, v21, v21 row_ror:8 row_mask:0xf bank_mask:0xc
    s_movk_i32 s15, 24576
    buffer_load_dwordx4 v[124:127], v6, s[48:51], s15 offen nt
    v_dot2_f32_bf16 v20, v100, v8, 0
    v_dot2_f32_bf16 v21, v96, v8, 0
    v_dot2_f32_bf16 v20, v101, v9, v20
    v_dot2_f32_bf16 v21, v97, v9, v21
    v_dot2_f32_bf16 v20, v102, v10, v20
    v_dot2_f32_bf16 v21, v98, v10, v21
    v_dot2_f32_bf16 v20, v103, v11, v20
    v_dot2_f32_bf16 v21, v99, v11, v21
    s_nop 1
    v_add_f32_dpp v23, v20, v20 row_ror:8 row_mask:0xf bank_mask:0x3
    s_nop 1
    v_add_f32_dpp v23, v21, v21 row_ror:8 row_mask:0xf bank_mask:0xc
    v_add_f32_dpp v25, v22, v22 row_half_mirror row_mask:0xf bank_mask:0x5
    s_nop 1
    v_add_f32_dpp v25, v23, v23 row_half_mirror row_mask:0xf bank_mask:0xa
    v_cndmask_b32 v28, v24, v25, s[64:65]
    v_cndmask_b32 v29, v25, v24, s[64:65]
    s_nop 1
    v_add_f32_dpp v26, v29, v28 quad_perm:[2,3,0,1] row_mask:0xf bank_mask:0xf
    v_dot2_f32_bf16 v20, v92, v8, 0
    v_dot2_f32_bf16 v21, v88, v8, 0
    v_dot2_f32_bf16 v20, v93, v9, v20
    v_dot2_f32_bf16 v21, v89, v9, v21
    v_dot2_f32_bf16 v20, v94, v10, v20
    v_dot2_f32_bf16 v21, v90, v10, v21
    v_dot2_f32_bf16 v20, v95, v11, v20
    v_dot2_f32_bf16 v21, v91, v11, v21
    s_nop 1
    v_add_f32_dpp v22, v20, v20 row_ror:8 row_mask:0xf bank_mask:0x3
    s_nop 1
    v_add_f32_dpp v22, v21, v21 row_ror:8 row_mask:0xf bank_mask:0xc
    v_dot2_f32_bf16 v20, v84, v8, 0
    v_dot2_f32_bf16 v21, v80, v8, 0
    v_dot2_f32_bf16 v20, v85, v9, v20
    v_dot2_f32_bf16 v21, v81, v9, v21
    v_dot2_f32_bf16 v20, v86, v10, v20
    v_dot2_f32_bf16 v21, v82, v10, v21
    v_dot2_f32_bf16 v20, v87, v11, v20
    v_dot2_f32_bf16 v21, v83, v11, v21
    s_nop 1
    v_add_f32_dpp v23, v20, v20 row_ror:8 row_mask:0xf bank_mask:0x3
    s_nop 1
    v_add_f32_dpp v23, v21, v21 row_ror:8 row_mask:0xf bank_mask:0xc
    v_add_f32_dpp v24, v22, v22 row_half_mirror row_mask:0xf bank_mask:0x5
    s_nop 1
    v_add_f32_dpp v24, v23, v23 row_half_mirror row_mask:0xf bank_mask:0xa
    s_waitcnt vmcnt(2)
    s_movk_i32 s15, 25600
    buffer_load_dwordx4 v[120:123], v6, s[48:51], s15 offen nt
    v_dot2_f32_bf16 v20, v76, v8, 0
    v_dot2_f32_bf16 v21, v72, v8, 0
    v_dot2_f32_bf16 v20, v77, v9, v20
    v_dot2_f32_bf16 v21, v73, v9, v21
    v_dot2_f32_bf16 v20, v78, v10, v20
    v_dot2_f32_bf16 v21, v74, v10, v21
    v_dot2_f32_bf16 v20, v79, v11, v20
    v_dot2_f32_bf16 v21, v75, v11, v21
    s_nop 1
    v_add_f32_dpp v22, v20, v20 row_ror:8 row_mask:0xf bank_mask:0x3
    s_nop 1
    v_add_f32_dpp v22, v21, v21 row_ror:8 row_mask:0xf bank_mask:0xc
    v_dot2_f32_bf16 v20, v68, v8, 0
    v_dot2_f32_bf16 v21, v64, v8, 0
    v_dot2_f32_bf16 v20, v69, v9, v20
    v_dot2_f32_bf16 v21, v65, v9, v21
    v_dot2_f32_bf16 v20, v70, v10, v20
    v_dot2_f32_bf16 v21, v66, v10, v21
    v_dot2_f32_bf16 v20, v71, v11, v20
    v_dot2_f32_bf16 v21, v67, v11, v21
    s_nop 1
    v_add_f32_dpp v23, v20, v20 row_ror:8 row_mask:0xf bank_mask:0x3
    s_nop 1
    v_add_f32_dpp v23, v21, v21 row_ror:8 row_mask:0xf bank_mask:0xc
    v_add_f32_dpp v25, v22, v22 row_half_mirror row_mask:0xf bank_mask:0x5
    s_nop 1
    v_add_f32_dpp v25, v23, v23 row_half_mirror row_mask:0xf bank_mask:0xa
    v_cndmask_b32 v28, v24, v25, s[64:65]
    v_cndmask_b32 v29, v25, v24, s[64:65]
    s_nop 1
    v_add_f32_dpp v27, v29, v28 quad_perm:[2,3,0,1] row_mask:0xf bank_mask:0xf
    v_cndmask_b32 v28, v26, v27, s[66:67]
    v_cndmask_b32 v29, v27, v26, s[66:67]
    s_nop 1
    v_add_f32_dpp v16, v29, v28 quad_perm:[1,0,3,2] row_mask:0xf bank_mask:0xf
    v_dot2_f32_bf16 v20, v60, v8, 0
    v_dot2_f32_bf16 v21, v56, v8, 0
    v_dot2_f32_bf16 v20, v61, v9, v20
    v_dot2_f32_bf16 v21, v57, v9, v21
    v_dot2_f32_bf16 v20, v62, v10, v20
    v_dot2_f32_bf16 v21, v58, v10, v21
    v_dot2_f32_bf16 v20, v63, v11, v20
    v_dot2_f32_bf16 v21, v59, v11, v21
    s_nop 1
    v_add_f32_dpp v22, v20, v20 row_ror:8 row_mask:0xf bank_mask:0x3
    s_nop 1
    v_add_f32_dpp v22, v21, v21 row_ror:8 row_mask:0xf bank_mask:0xc
    s_waitcnt vmcnt(2)
    s_movk_i32 s15, 26624
    buffer_load_dwordx4 v[116:119], v6, s[48:51], s15 offen nt
    v_dot2_f32_bf16 v20, v52, v8, 0
    v_dot2_f32_bf16 v21, v48, v8, 0
    v_dot2_f32_bf16 v20, v53, v9, v20
    v_dot2_f32_bf16 v21, v49, v9, v21
    v_dot2_f32_bf16 v20, v54, v10, v20
    v_dot2_f32_bf16 v21, v50, v10, v21
    v_dot2_f32_bf16 v20, v55, v11, v20
    v_dot2_f32_bf16 v21, v51, v11, v21
    s_nop 1
    v_add_f32_dpp v23, v20, v20 row_ror:8 row_mask:0xf bank_mask:0x3
    s_nop 1
    v_add_f32_dpp v23, v21, v21 row_ror:8 row_mask:0xf bank_mask:0xc
    v_add_f32_dpp v24, v22, v22 row_half_mirror row_mask:0xf bank_mask:0x5
    s_nop 1
    v_add_f32_dpp v24, v23, v23 row_half_mirror row_mask:0xf bank_mask:0xa
    v_dot2_f32_bf16 v20, v44, v8, 0
    v_dot2_f32_bf16 v21, v40, v8, 0
    v_dot2_f32_bf16 v20, v45, v9, v20
    v_dot2_f32_bf16 v21, v41, v9, v21
    v_dot2_f32_bf16 v20, v46, v10, v20
    v_dot2_f32_bf16 v21, v42, v10, v21
    v_dot2_f32_bf16 v20, v47, v11, v20
    v_dot2_f32_bf16 v21, v43, v11, v21
    s_nop 1
    v_add_f32_dpp v22, v20, v20 row_ror:8 row_mask:0xf bank_mask:0x3
    s_nop 1
    v_add_f32_dpp v22, v21, v21 row_ror:8 row_mask:0xf bank_mask:0xc
    v_dot2_f32_bf16 v20, v36, v8, 0
    v_dot2_f32_bf16 v21, v32, v8, 0
    v_dot2_f32_bf16 v20, v37, v9, v20
    v_dot2_f32_bf16 v21, v33, v9, v21
    v_dot2_f32_bf16 v20, v38, v10, v20
    v_dot2_f32_bf16 v21, v34, v10, v21
    v_dot2_f32_bf16 v20, v39, v11, v20
    v_dot2_f32_bf16 v21, v35, v11, v21
    s_nop 1
    v_add_f32_dpp v23, v20, v20 row_ror:8 row_mask:0xf bank_mask:0x3
    s_nop 1
    v_add_f32_dpp v23, v21, v21 row_ror:8 row_mask:0xf bank_mask:0xc
    v_add_f32_dpp v25, v22, v22 row_half_mirror row_mask:0xf bank_mask:0x5
    s_nop 1
    v_add_f32_dpp v25, v23, v23 row_half_mirror row_mask:0xf bank_mask:0xa
    v_cndmask_b32 v28, v24, v25, s[64:65]
    v_cndmask_b32 v29, v25, v24, s[64:65]
    s_nop 1
    v_add_f32_dpp v26, v29, v28 quad_perm:[2,3,0,1] row_mask:0xf bank_mask:0xf
    s_waitcnt vmcnt(2)
    s_movk_i32 s15, 27648
    buffer_load_dwordx4 v[112:115], v6, s[48:51], s15 offen nt
    s_waitcnt vmcnt(2)
    s_movk_i32 s15, 28672
    buffer_load_dwordx4 v[108:111], v6, s[48:51], s15 offen nt
    v_dot2_f32_bf16 v20, v124, v8, 0
    v_dot2_f32_bf16 v21, v120, v8, 0
    v_dot2_f32_bf16 v20, v125, v9, v20
    v_dot2_f32_bf16 v21, v121, v9, v21
    v_dot2_f32_bf16 v20, v126, v10, v20
    v_dot2_f32_bf16 v21, v122, v10, v21
    v_dot2_f32_bf16 v20, v127, v11, v20
    v_dot2_f32_bf16 v21, v123, v11, v21
    s_nop 1
    v_add_f32_dpp v22, v20, v20 row_ror:8 row_mask:0xf bank_mask:0x3
    s_nop 1
    v_add_f32_dpp v22, v21, v21 row_ror:8 row_mask:0xf bank_mask:0xc
    s_waitcnt vmcnt(2)
    s_movk_i32 s15, 29696
    buffer_load_dwordx4 v[124:127], v6, s[48:51], s15 offen nt
    s_waitcnt vmcnt(2)
    s_movk_i32 s15, 30720
    buffer_load_dwordx4 v[120:123], v6, s[48:51], s15 offen nt
    v_dot2_f32_bf16 v20, v116, v8, 0
    v_dot2_f32_bf16 v21, v112, v8, 0
    v_dot2_f32_bf16 v20, v117, v9, v20
    v_dot2_f32_bf16 v21, v113, v9, v21
    v_dot2_f32_bf16 v20, v118, v10, v20
    v_dot2_f32_bf16 v21, v114, v10, v21
    v_dot2_f32_bf16 v20, v119, v11, v20
    v_dot2_f32_bf16 v21, v115, v11, v21
    s_nop 1
    v_add_f32_dpp v23, v20, v20 row_ror:8 row_mask:0xf bank_mask:0x3
    s_nop 1
    v_add_f32_dpp v23, v21, v21 row_ror:8 row_mask:0xf bank_mask:0xc
    v_add_f32_dpp v24, v22, v22 row_half_mirror row_mask:0xf bank_mask:0x5
    s_nop 1
    v_add_f32_dpp v24, v23, v23 row_half_mirror row_mask:0xf bank_mask:0xa
    s_waitcnt vmcnt(2)
    s_movk_i32 s15, 31744
    buffer_load_dwordx4 v[116:119], v6, s[48:51], s15 offen nt
    s_waitcnt vmcnt(2)
    s_movk_i32 s15, 0
    buffer_load_dwordx4 v[32:35], v7, s[52:55], s15 offen nt
    s_cmp_lt_u32 s4, 4
    s_cselect_b32 s56, s28, s30
    s_cselect_b32 s57, s29, s31
    s_and_b32 s57, s57, 0xffff
    s_cmp_lt_u32 s8, 18
    s_cselect_b32 s58, 5308416, 0
    s_mov_b32 s59, 0x20000
    s_lshl_b32 s60, s10, 6
    s_and_b32 s61, s4, 3
    s_mul_i32 s62, s61, 147456
    s_add_u32 s60, s60, s62
    v_lshrrev_b32 v6, 2, v1
    v_mul_u32_u24 v6, 9216, v6
    v_and_b32 v4, 3, v1
    v_lshl_add_u32 v6, v4, 4, v6
    v_add_u32 v6, s60, v6
    s_lshr_b32 s62, s4, 2
    s_mul_i32 s62, s62, 36864
    s_lshl_b32 s61, s61, 10
    s_add_u32 s61, s61, s62
    s_add_u32 s61, s61, 12288
    s_mov_b32 s62, 0
    v_dot2_f32_bf16 v20, v108, v8, 0
    v_dot2_f32_bf16 v21, v124, v8, 0
    v_dot2_f32_bf16 v20, v109, v9, v20
    v_dot2_f32_bf16 v21, v125, v9, v21
    v_dot2_f32_bf16 v20, v110, v10, v20
    v_dot2_f32_bf16 v21, v126, v10, v21
    v_dot2_f32_bf16 v20, v111, v11, v20
    v_dot2_f32_bf16 v21, v127, v11, v21
    s_nop 1
    v_add_f32_dpp v22, v20, v20 row_ror:8 row_mask:0xf bank_mask:0x3
    s_nop 1
    v_add_f32_dpp v22, v21, v21 row_ror:8 row_mask:0xf bank_mask:0xc
    s_waitcnt vmcnt(2)
    s_movk_i32 s15, 2048
    buffer_load_dwordx4 v[36:39], v7, s[52:55], s15 offen nt
    s_waitcnt vmcnt(2)
    s_movk_i32 s15, 4096
    buffer_load_dwordx4 v[40:43], v7, s[52:55], s15 offen nt
    v_dot2_f32_bf16 v20, v120, v8, 0
    v_dot2_f32_bf16 v21, v116, v8, 0
    v_dot2_f32_bf16 v20, v121, v9, v20
    v_dot2_f32_bf16 v21, v117, v9, v21
    v_dot2_f32_bf16 v20, v122, v10, v20
    v_dot2_f32_bf16 v21, v118, v10, v21
    v_dot2_f32_bf16 v20, v123, v11, v20
    v_dot2_f32_bf16 v21, v119, v11, v21
    s_nop 1
    v_add_f32_dpp v23, v20, v20 row_ror:8 row_mask:0xf bank_mask:0x3
    s_nop 1
    v_add_f32_dpp v23, v21, v21 row_ror:8 row_mask:0xf bank_mask:0xc
    v_add_f32_dpp v25, v22, v22 row_half_mirror row_mask:0xf bank_mask:0x5
    s_nop 1
    v_add_f32_dpp v25, v23, v23 row_half_mirror row_mask:0xf bank_mask:0xa
    v_cndmask_b32 v28, v24, v25, s[64:65]
    v_cndmask_b32 v29, v25, v24, s[64:65]
    s_nop 1
    v_add_f32_dpp v27, v29, v28 quad_perm:[2,3,0,1] row_mask:0xf bank_mask:0xf
    v_cndmask_b32 v28, v26, v27, s[66:67]
    v_cndmask_b32 v29, v27, v26, s[66:67]
    s_nop 1
    v_add_f32_dpp v17, v29, v28 quad_perm:[1,0,3,2] row_mask:0xf bank_mask:0xf
    v_cvt_pk_bf16_f32 v20, v16, v17
    s_mov_b32 s11, 0x3db504f3
    v_lshlrev_b32 v16, 16, v20
    v_and_b32 v17, 0xffff0000, v20
    v_mul_f32 v16, s11, v16
    v_mul_f32 v17, s11, v17
    v_cvt_pk_bf16_f32 v20, v16, v17
    v_lshlrev_b32 v16, 16, v20
    v_and_b32 v17, 0xffff0000, v20
    v_max_f32 v22, v16, v17
    s_nop 1
    v_max_f32_dpp v22, v22, v22 row_ror:8 row_mask:0xf bank_mask:0xf
    s_nop 1
    v_max_f32_dpp v22, v22, v22 row_ror:4 row_mask:0xf bank_mask:0xf
    s_nop 1
    v_max_f32_dpp v22, v22, v22 row_ror:2 row_mask:0xf bank_mask:0xf
    s_nop 1
    v_max_f32_dpp v22, v22, v22 row_ror:1 row_mask:0xf bank_mask:0xf
    v_mov_b32 v21, v22
    s_nop 1
    v_permlane16_swap_b32 v22, v21
    v_max_f32 v22, v22, v21
    v_mov_b32 v21, v22
    s_nop 1
    v_permlane32_swap_b32 v22, v21
    v_max_f32 v22, v22, v21
    s_mov_b32 s11, 0x3fb8aa3b
    v_sub_f32 v16, v16, v22
    v_sub_f32 v17, v17, v22
    v_mul_f32 v16, s11, v16
    v_mul_f32 v17, s11, v17
    v_exp_f32 v16, v16
    v_exp_f32 v17, v17
    s_nop 0
    v_add_f32 v23, v16, v17
    v_cvt_pk_bf16_f32 v16, v16, v16
    v_cvt_pk_bf16_f32 v17, v17, v17
    s_mov_b32 s14, 0xffff
    v_bfi_b32 v20, s14, v0, v16
    v_bfi_b32 v21, s14, v0, v17
    s_lshl_b32 s11, s3, 3
    s_add_u32 s11, s11, s4
    s_lshl_b32 s12, s11, 9
    s_add_u32 s12, s12, 3145728
    v_lshlrev_b32 v31, 3, v1
    buffer_store_dwordx2 v[20:21], v31, s[44:47], s12 offen sc1
    s_xor_b32 s13, s12, 0x1000
    v_add_f32_dpp v23, v23, v23 row_ror:8 row_mask:0xf bank_mask:0xf
    s_nop 1
    v_add_f32_dpp v23, v23, v23 row_ror:4 row_mask:0xf bank_mask:0xf
    s_nop 1
    v_add_f32_dpp v23, v23, v23 row_ror:2 row_mask:0xf bank_mask:0xf
    s_nop 1
    v_add_f32_dpp v23, v23, v23 row_ror:1 row_mask:0xf bank_mask:0xf
    v_mov_b32 v25, v23
    s_nop 1
    v_permlane16_swap_b32 v23, v25
    v_add_f32 v23, v23, v25
    v_mov_b32 v25, v23
    s_nop 1
    v_permlane32_swap_b32 v23, v25
    v_add_f32 v23, v23, v25
    v_bfi_b32 v22, s96, v0, v22
    v_bfi_b32 v23, s96, v0, v23
    v_cmp_eq_u32 vcc, 0, v1
    v_mov_b32 v24, 1073741824
    s_nop 0
    v_cndmask_b32 v24, v24, v5, vcc
    s_lshl_b32 s11, s11, 3
    s_add_u32 s11, s11, 2039808
    buffer_store_dwordx2 v[22:23], v24, s[44:47], s11 offen sc1
    s_waitcnt vmcnt(2)
    s_movk_i32 s15, 6144
    buffer_load_dwordx4 v[44:47], v7, s[52:55], s15 offen nt
    s_mov_b32 m0, s61
    s_mov_b32 exec_hi, 0
    buffer_load_dwordx4 v6, s[56:59], s62 offen lds
    s_mov_b64 exec, -1
    s_waitcnt vmcnt(3)
    s_cmp_gt_u32 s63, 1
    s_cbranch_scc1 Llv_3
    s_waitcnt vmcnt(2)
Llv_3:
    s_movk_i32 s15, 8192
    buffer_load_dwordx4 v[48:51], v7, s[52:55], s15 offen nt
    s_mov_b32 m0, s61
    s_mov_b32 exec_lo, 0
    buffer_load_dwordx4 v6, s[56:59], s62 offen lds
    s_mov_b64 exec, -1
    s_add_u32 s61, s61, 4096
    s_add_u32 s62, s62, 589824
    s_waitcnt vmcnt(3)
    s_cmp_gt_u32 s63, 5
    s_cbranch_scc1 Llv_4
    s_waitcnt vmcnt(2)
Llv_4:
    s_movk_i32 s15, 10240
    buffer_load_dwordx4 v[52:55], v7, s[52:55], s15 offen nt
    s_waitcnt vmcnt(3)
    s_cmp_gt_u32 s63, 3
    s_cbranch_scc1 Llv_5
    s_waitcnt vmcnt(2)
Llv_5:
    s_movk_i32 s15, 12288
    buffer_load_dwordx4 v[56:59], v7, s[52:55], s15 offen nt
    s_mov_b32 m0, s61
    s_mov_b32 exec_hi, 0
    buffer_load_dwordx4 v6, s[56:59], s62 offen lds
    s_mov_b64 exec, -1
    s_waitcnt vmcnt(3)
    s_cmp_gt_u32 s63, 7
    s_cbranch_scc1 Llv_6
    s_waitcnt vmcnt(2)
Llv_6:
    s_movk_i32 s15, 14336
    buffer_load_dwordx4 v[60:63], v7, s[52:55], s15 offen nt
    s_mov_b32 m0, s61
    s_mov_b32 exec_lo, 0
    buffer_load_dwordx4 v6, s[56:59], s62 offen lds
    s_mov_b64 exec, -1
    s_add_u32 s61, s61, 4096
    s_add_u32 s62, s62, 589824
    s_waitcnt vmcnt(3)
    s_cmp_gt_u32 s63, 0
    s_cbranch_scc1 Llv_7
    s_waitcnt vmcnt(2)
Llv_7:
    s_movk_i32 s15, 16384
    buffer_load_dwordx4 v[64:67], v7, s[52:55], s15 offen nt
    s_waitcnt vmcnt(3)
    s_cmp_gt_u32 s63, 4
    s_cbranch_scc1 Llv_8
    s_waitcnt vmcnt(2)
Llv_8:
    s_movk_i32 s15, 18432
    buffer_load_dwordx4 v[68:71], v7, s[52:55], s15 offen nt
    s_mov_b32 m0, s61
    s_mov_b32 exec_hi, 0
    buffer_load_dwordx4 v6, s[56:59], s62 offen lds
    s_mov_b64 exec, -1
    s_waitcnt vmcnt(3)
    s_cmp_gt_u32 s63, 2
    s_cbranch_scc1 Llv_9
    s_waitcnt vmcnt(2)
Llv_9:
    buffer_load_dwordx2 v[26:27], v31, s[44:47], s13 offen sc1
    s_movk_i32 s15, 20480
    buffer_load_dwordx4 v[72:75], v7, s[52:55], s15 offen nt
    s_mov_b32 m0, s61
    s_mov_b32 exec_lo, 0
    buffer_load_dwordx4 v6, s[56:59], s62 offen lds
    s_mov_b64 exec, -1
    s_add_u32 s61, s61, 4096
    s_add_u32 s62, s62, 589824
    s_waitcnt vmcnt(3)
    s_cmp_gt_u32 s63, 6
    s_cbranch_scc1 Llv_10
    s_waitcnt vmcnt(2)
Llv_10:
    s_movk_i32 s15, 22528
    buffer_load_dwordx4 v[76:79], v7, s[52:55], s15 offen nt
    s_waitcnt vmcnt(3)
    s_cmp_gt_u32 s63, 1
    s_cbranch_scc1 Llv_11
    s_waitcnt vmcnt(2)
Llv_11:
    s_movk_i32 s15, 24576
    buffer_load_dwordx4 v[80:83], v7, s[52:55], s15 offen nt
    s_mov_b32 m0, s61
    s_mov_b32 exec_hi, 0
    buffer_load_dwordx4 v6, s[56:59], s62 offen lds
    s_mov_b64 exec, -1
    s_branch Lpoc_14
Lpo_12:
    buffer_load_dwordx2 v[26:27], v31, s[44:47], s13 offen sc1
    s_waitcnt vmcnt(0)
Lpoc_14:
    v_xor_b32 v28, v26, v0
    v_bitop3_b32 v28, v28, v27, v0 bitop3:0xf6
    v_and_b32 v28, s96, v28
    v_cmp_ne_u32 vcc, 0, v28
    s_cbranch_vccz Lpod_13
    s_sub_u32 s70, s70, 1
    s_cmp_gt_i32 s70, 0
    s_cbranch_scc1 Lpo_12
Lpod_13:
    s_mov_b32 s14, 0x03020302
    v_perm_b32 v18, v26, v26, s14
    v_perm_b32 v19, v27, v27, s14
    s_bitcmp0_b32 s7, 0
    s_cbranch_scc1 Lsw_15
    v_swap_b32 v16, v18
    v_swap_b32 v17, v19
Lsw_15:
    s_nop 1
    v_mov_b32_dpp v20, v16 row_newbcast:0 row_mask:0xf bank_mask:0x3
    s_nop 1
    v_mov_b32_dpp v20, v16 row_newbcast:8 row_mask:0xf bank_mask:0xc
    v_and_b32 v112, v20, v12
    v_and_b32 v113, v20, v13
    v_and_b32 v114, v20, v14
    v_and_b32 v115, v20, v15
    s_nop 1
    v_mfma_f32_16x16x32_bf16 v[120:123], v[112:115], v[32:35], 0
    v_mov_b32_dpp v21, v16 row_newbcast:4 row_mask:0xf bank_mask:0x3
    s_nop 1
    v_mov_b32_dpp v21, v16 row_newbcast:12 row_mask:0xf bank_mask:0xc
    v_and_b32 v116, v21, v12
    v_and_b32 v117, v21, v13
    v_and_b32 v118, v21, v14
    v_and_b32 v119, v21, v15
    s_nop 1
    v_mfma_f32_16x16x32_bf16 v[120:123], v[116:119], v[36:39], v[120:123]
    v_mov_b32_dpp v20, v16 row_newbcast:2 row_mask:0xf bank_mask:0x3
    s_nop 1
    v_mov_b32_dpp v20, v16 row_newbcast:10 row_mask:0xf bank_mask:0xc
    v_and_b32 v112, v20, v12
    v_and_b32 v113, v20, v13
    v_and_b32 v114, v20, v14
    v_and_b32 v115, v20, v15
    s_nop 1
    v_mfma_f32_16x16x32_bf16 v[120:123], v[112:115], v[40:43], v[120:123]
    v_mov_b32_dpp v21, v16 row_newbcast:6 row_mask:0xf bank_mask:0x3
    s_nop 1
    v_mov_b32_dpp v21, v16 row_newbcast:14 row_mask:0xf bank_mask:0xc
    v_and_b32 v116, v21, v12
    v_and_b32 v117, v21, v13
    v_and_b32 v118, v21, v14
    v_and_b32 v119, v21, v15
    s_nop 1
    v_mfma_f32_16x16x32_bf16 v[120:123], v[116:119], v[44:47], v[120:123]
    v_mov_b32_dpp v20, v16 row_newbcast:1 row_mask:0xf bank_mask:0x3
    s_nop 1
    v_mov_b32_dpp v20, v16 row_newbcast:9 row_mask:0xf bank_mask:0xc
    v_and_b32 v112, v20, v12
    v_and_b32 v113, v20, v13
    v_and_b32 v114, v20, v14
    v_and_b32 v115, v20, v15
    s_nop 1
    v_mfma_f32_16x16x32_bf16 v[120:123], v[112:115], v[48:51], v[120:123]
    v_mov_b32_dpp v21, v16 row_newbcast:5 row_mask:0xf bank_mask:0x3
    s_nop 1
    v_mov_b32_dpp v21, v16 row_newbcast:13 row_mask:0xf bank_mask:0xc
    v_and_b32 v116, v21, v12
    v_and_b32 v117, v21, v13
    v_and_b32 v118, v21, v14
    v_and_b32 v119, v21, v15
    s_nop 1
    v_mfma_f32_16x16x32_bf16 v[120:123], v[116:119], v[52:55], v[120:123]
    s_waitcnt vmcnt(3)
    s_cmp_gt_u32 s63, 5
    s_cbranch_scc1 Llv_16
    s_waitcnt vmcnt(2)
Llv_16:
    s_movk_i32 s15, 26624
    buffer_load_dwordx4 v[32:35], v7, s[52:55], s15 offen nt
    s_mov_b32 m0, s61
    s_mov_b32 exec_lo, 0
    buffer_load_dwordx4 v6, s[56:59], s62 offen lds
    s_mov_b64 exec, -1
    s_add_u32 s61, s61, 4096
    s_add_u32 s62, s62, 589824
    v_mov_b32_dpp v20, v16 row_newbcast:3 row_mask:0xf bank_mask:0x3
    s_nop 1
    v_mov_b32_dpp v20, v16 row_newbcast:11 row_mask:0xf bank_mask:0xc
    v_and_b32 v112, v20, v12
    v_and_b32 v113, v20, v13
    v_and_b32 v114, v20, v14
    v_and_b32 v115, v20, v15
    s_nop 1
    v_mfma_f32_16x16x32_bf16 v[120:123], v[112:115], v[56:59], v[120:123]
    v_mov_b32_dpp v21, v16 row_newbcast:7 row_mask:0xf bank_mask:0x3
    s_nop 1
    v_mov_b32_dpp v21, v16 row_newbcast:15 row_mask:0xf bank_mask:0xc
    v_and_b32 v116, v21, v12
    v_and_b32 v117, v21, v13
    v_and_b32 v118, v21, v14
    v_and_b32 v119, v21, v15
    s_nop 1
    v_mfma_f32_16x16x32_bf16 v[120:123], v[116:119], v[60:63], v[120:123]
    v_mov_b32_dpp v20, v17 row_newbcast:0 row_mask:0xf bank_mask:0x3
    s_nop 1
    v_mov_b32_dpp v20, v17 row_newbcast:8 row_mask:0xf bank_mask:0xc
    v_and_b32 v112, v20, v12
    v_and_b32 v113, v20, v13
    v_and_b32 v114, v20, v14
    v_and_b32 v115, v20, v15
    s_nop 1
    v_mfma_f32_16x16x32_bf16 v[120:123], v[112:115], v[64:67], v[120:123]
    v_mov_b32_dpp v21, v17 row_newbcast:4 row_mask:0xf bank_mask:0x3
    s_nop 1
    v_mov_b32_dpp v21, v17 row_newbcast:12 row_mask:0xf bank_mask:0xc
    v_and_b32 v116, v21, v12
    v_and_b32 v117, v21, v13
    v_and_b32 v118, v21, v14
    v_and_b32 v119, v21, v15
    s_nop 1
    v_mfma_f32_16x16x32_bf16 v[120:123], v[116:119], v[68:71], v[120:123]
    s_waitcnt vmcnt(3)
    s_cmp_gt_u32 s63, 3
    s_cbranch_scc1 Llv_17
    s_waitcnt vmcnt(2)
Llv_17:
    s_movk_i32 s15, 28672
    buffer_load_dwordx4 v[36:39], v7, s[52:55], s15 offen nt
    v_mov_b32_dpp v20, v17 row_newbcast:2 row_mask:0xf bank_mask:0x3
    s_nop 1
    v_mov_b32_dpp v20, v17 row_newbcast:10 row_mask:0xf bank_mask:0xc
    v_and_b32 v112, v20, v12
    v_and_b32 v113, v20, v13
    v_and_b32 v114, v20, v14
    v_and_b32 v115, v20, v15
    s_nop 1
    v_mfma_f32_16x16x32_bf16 v[120:123], v[112:115], v[72:75], v[120:123]
    s_waitcnt vmcnt(3)
    s_cmp_gt_u32 s63, 7
    s_cbranch_scc1 Llv_18
    s_waitcnt vmcnt(2)
Llv_18:
    s_movk_i32 s15, 30720
    buffer_load_dwordx4 v[40:43], v7, s[52:55], s15 offen nt
    s_mov_b32 m0, s61
    s_mov_b32 exec_hi, 0
    buffer_load_dwordx4 v6, s[56:59], s62 offen lds
    s_mov_b64 exec, -1
    v_mov_b32_dpp v21, v17 row_newbcast:6 row_mask:0xf bank_mask:0x3
    s_nop 1
    v_mov_b32_dpp v21, v17 row_newbcast:14 row_mask:0xf bank_mask:0xc
    v_and_b32 v116, v21, v12
    v_and_b32 v117, v21, v13
    v_and_b32 v118, v21, v14
    v_and_b32 v119, v21, v15
    s_nop 1
    v_mfma_f32_16x16x32_bf16 v[120:123], v[116:119], v[76:79], v[120:123]
    s_waitcnt vmcnt(3)
    s_cmp_gt_u32 s63, 0
    s_cbranch_scc1 Llv_19
    s_waitcnt vmcnt(2)
Llv_19:
    s_movk_i32 s15, 0
    buffer_load_dwordx4 v[44:47], v30, s[52:55], s15 offen nt
    s_mov_b32 m0, s61
    s_mov_b32 exec_lo, 0
    buffer_load_dwordx4 v6, s[56:59], s62 offen lds
    s_mov_b64 exec, -1
    s_add_u32 s61, s61, 4096
    s_add_u32 s62, s62, 589824
    v_mov_b32_dpp v20, v17 row_newbcast:1 row_mask:0xf bank_mask:0x3
    s_nop 1
    v_mov_b32_dpp v20, v17 row_newbcast:9 row_mask:0xf bank_mask:0xc
    v_and_b32 v112, v20, v12
    v_and_b32 v113, v20, v13
    v_and_b32 v114, v20, v14
    v_and_b32 v115, v20, v15
    s_nop 1
    v_mfma_f32_16x16x32_bf16 v[120:123], v[112:115], v[80:83], v[120:123]
    s_waitcnt vmcnt(3)
    s_cmp_gt_u32 s63, 4
    s_cbranch_scc1 Llv_20
    s_waitcnt vmcnt(2)
Llv_20:
    s_movk_i32 s15, 2048
    buffer_load_dwordx4 v[48:51], v30, s[52:55], s15 offen nt
    v_mov_b32_dpp v21, v17 row_newbcast:5 row_mask:0xf bank_mask:0x3
    s_nop 1
    v_mov_b32_dpp v21, v17 row_newbcast:13 row_mask:0xf bank_mask:0xc
    v_and_b32 v116, v21, v12
    v_and_b32 v117, v21, v13
    v_and_b32 v118, v21, v14
    v_and_b32 v119, v21, v15
    s_nop 1
    v_mfma_f32_16x16x32_bf16 v[120:123], v[116:119], v[32:35], v[120:123]
    s_waitcnt vmcnt(3)
    s_cmp_gt_u32 s63, 2
    s_cbranch_scc1 Llv_21
    s_waitcnt vmcnt(2)
Llv_21:
    s_movk_i32 s15, 4096
    buffer_load_dwordx4 v[32:35], v30, s[52:55], s15 offen nt
    s_mov_b32 m0, s61
    s_mov_b32 exec_hi, 0
    buffer_load_dwordx4 v6, s[56:59], s62 offen lds
    s_mov_b64 exec, -1
    v_mov_b32_dpp v20, v17 row_newbcast:3 row_mask:0xf bank_mask:0x3
    s_nop 1
    v_mov_b32_dpp v20, v17 row_newbcast:11 row_mask:0xf bank_mask:0xc
    v_and_b32 v112, v20, v12
    v_and_b32 v113, v20, v13
    v_and_b32 v114, v20, v14
    v_and_b32 v115, v20, v15
    s_nop 1
    v_mfma_f32_16x16x32_bf16 v[120:123], v[112:115], v[36:39], v[120:123]
    s_waitcnt vmcnt(3)
    s_cmp_gt_u32 s63, 6
    s_cbranch_scc1 Llv_22
    s_waitcnt vmcnt(2)
Llv_22:
    s_movk_i32 s15, 6144
    buffer_load_dwordx4 v[36:39], v30, s[52:55], s15 offen nt
    s_mov_b32 m0, s61
    s_mov_b32 exec_lo, 0
    buffer_load_dwordx4 v6, s[56:59], s62 offen lds
    s_mov_b64 exec, -1
    s_add_u32 s61, s61, 4096
    s_add_u32 s62, s62, 589824
    v_mov_b32_dpp v21, v17 row_newbcast:7 row_mask:0xf bank_mask:0x3
    s_nop 1
    v_mov_b32_dpp v21, v17 row_newbcast:15 row_mask:0xf bank_mask:0xc
    v_and_b32 v116, v21, v12
    v_and_b32 v117, v21, v13
    v_and_b32 v118, v21, v14
    v_and_b32 v119, v21, v15
    s_nop 1
    v_mfma_f32_16x16x32_bf16 v[120:123], v[116:119], v[40:43], v[120:123]
    s_waitcnt vmcnt(3)
    s_cmp_gt_u32 s63, 1
    s_cbranch_scc1 Llv_23
    s_waitcnt vmcnt(2)
Llv_23:
    s_movk_i32 s15, 8192
    buffer_load_dwordx4 v[40:43], v30, s[52:55], s15 offen nt
    v_mov_b32_dpp v20, v18 row_newbcast:0 row_mask:0xf bank_mask:0x3
    s_nop 1
    v_mov_b32_dpp v20, v18 row_newbcast:8 row_mask:0xf bank_mask:0xc
    v_and_b32 v112, v20, v12
    v_and_b32 v113, v20, v13
    v_and_b32 v114, v20, v14
    v_and_b32 v115, v20, v15
    s_nop 1
    v_mfma_f32_16x16x32_bf16 v[124:127], v[112:115], v[44:47], 0
    s_waitcnt vmcnt(3)
    s_cmp_gt_u32 s63, 5
    s_cbranch_scc1 Llv_24
    s_waitcnt vmcnt(2)
Llv_24:
    s_movk_i32 s15, 10240
    buffer_load_dwordx4 v[44:47], v30, s[52:55], s15 offen nt
    s_mov_b32 m0, s61
    s_mov_b32 exec_hi, 0
    buffer_load_dwordx4 v6, s[56:59], s62 offen lds
    s_mov_b64 exec, -1
    v_mov_b32_dpp v21, v18 row_newbcast:4 row_mask:0xf bank_mask:0x3
    s_nop 1
    v_mov_b32_dpp v21, v18 row_newbcast:12 row_mask:0xf bank_mask:0xc
    v_and_b32 v116, v21, v12
    v_and_b32 v117, v21, v13
    v_and_b32 v118, v21, v14
    v_and_b32 v119, v21, v15
    s_nop 1
    v_mfma_f32_16x16x32_bf16 v[124:127], v[116:119], v[48:51], v[124:127]
    s_waitcnt vmcnt(3)
    s_cmp_gt_u32 s63, 3
    s_cbranch_scc1 Llv_25
    s_waitcnt vmcnt(2)
Llv_25:
    s_movk_i32 s15, 12288
    buffer_load_dwordx4 v[48:51], v30, s[52:55], s15 offen nt
    s_mov_b32 m0, s61
    s_mov_b32 exec_lo, 0
    buffer_load_dwordx4 v6, s[56:59], s62 offen lds
    s_mov_b64 exec, -1
    s_add_u32 s61, s61, 4096
    s_add_u32 s62, s62, 589824
    v_mov_b32_dpp v20, v18 row_newbcast:2 row_mask:0xf bank_mask:0x3
    s_nop 1
    v_mov_b32_dpp v20, v18 row_newbcast:10 row_mask:0xf bank_mask:0xc
    v_and_b32 v112, v20, v12
    v_and_b32 v113, v20, v13
    v_and_b32 v114, v20, v14
    v_and_b32 v115, v20, v15
    s_nop 1
    v_mfma_f32_16x16x32_bf16 v[124:127], v[112:115], v[32:35], v[124:127]
    s_waitcnt vmcnt(3)
    s_cmp_gt_u32 s63, 7
    s_cbranch_scc1 Llv_26
    s_waitcnt vmcnt(2)
Llv_26:
    s_movk_i32 s15, 14336
    buffer_load_dwordx4 v[32:35], v30, s[52:55], s15 offen nt
    v_mov_b32_dpp v21, v18 row_newbcast:6 row_mask:0xf bank_mask:0x3
    s_nop 1
    v_mov_b32_dpp v21, v18 row_newbcast:14 row_mask:0xf bank_mask:0xc
    v_and_b32 v116, v21, v12
    v_and_b32 v117, v21, v13
    v_and_b32 v118, v21, v14
    v_and_b32 v119, v21, v15
    s_nop 1
    v_mfma_f32_16x16x32_bf16 v[124:127], v[116:119], v[36:39], v[124:127]
    s_waitcnt vmcnt(3)
    s_cmp_gt_u32 s63, 0
    s_cbranch_scc1 Llv_27
    s_waitcnt vmcnt(2)
Llv_27:
    s_movk_i32 s15, 16384
    buffer_load_dwordx4 v[36:39], v30, s[52:55], s15 offen nt
    s_mov_b32 m0, s61
    s_mov_b32 exec_hi, 0
    buffer_load_dwordx4 v6, s[56:59], s62 offen lds
    s_mov_b64 exec, -1
    v_mov_b32_dpp v20, v18 row_newbcast:1 row_mask:0xf bank_mask:0x3
    s_nop 1
    v_mov_b32_dpp v20, v18 row_newbcast:9 row_mask:0xf bank_mask:0xc
    v_and_b32 v112, v20, v12
    v_and_b32 v113, v20, v13
    v_and_b32 v114, v20, v14
    v_and_b32 v115, v20, v15
    s_nop 1
    v_mfma_f32_16x16x32_bf16 v[124:127], v[112:115], v[40:43], v[124:127]
    s_waitcnt vmcnt(3)
    s_cmp_gt_u32 s63, 4
    s_cbranch_scc1 Llv_28
    s_waitcnt vmcnt(2)
Llv_28:
    s_movk_i32 s15, 18432
    buffer_load_dwordx4 v[40:43], v30, s[52:55], s15 offen nt
    s_mov_b32 m0, s61
    s_mov_b32 exec_lo, 0
    buffer_load_dwordx4 v6, s[56:59], s62 offen lds
    s_mov_b64 exec, -1
    s_add_u32 s61, s61, 4096
    s_add_u32 s62, s62, 589824
    v_mov_b32_dpp v21, v18 row_newbcast:5 row_mask:0xf bank_mask:0x3
    s_nop 1
    v_mov_b32_dpp v21, v18 row_newbcast:13 row_mask:0xf bank_mask:0xc
    v_and_b32 v116, v21, v12
    v_and_b32 v117, v21, v13
    v_and_b32 v118, v21, v14
    v_and_b32 v119, v21, v15
    s_nop 1
    v_mfma_f32_16x16x32_bf16 v[124:127], v[116:119], v[44:47], v[124:127]
    s_waitcnt vmcnt(3)
    s_cmp_gt_u32 s63, 2
    s_cbranch_scc1 Llv_29
    s_waitcnt vmcnt(2)
Llv_29:
    s_movk_i32 s15, 20480
    buffer_load_dwordx4 v[44:47], v30, s[52:55], s15 offen nt
    v_mov_b32_dpp v20, v18 row_newbcast:3 row_mask:0xf bank_mask:0x3
    s_nop 1
    v_mov_b32_dpp v20, v18 row_newbcast:11 row_mask:0xf bank_mask:0xc
    v_and_b32 v112, v20, v12
    v_and_b32 v113, v20, v13
    v_and_b32 v114, v20, v14
    v_and_b32 v115, v20, v15
    s_nop 1
    v_mfma_f32_16x16x32_bf16 v[124:127], v[112:115], v[48:51], v[124:127]
    s_waitcnt vmcnt(3)
    s_cmp_gt_u32 s63, 6
    s_cbranch_scc1 Llv_30
    s_waitcnt vmcnt(2)
Llv_30:
    s_movk_i32 s15, 22528
    buffer_load_dwordx4 v[48:51], v30, s[52:55], s15 offen nt
    s_mov_b32 m0, s61
    s_mov_b32 exec_hi, 0
    buffer_load_dwordx4 v6, s[56:59], s62 offen lds
    s_mov_b64 exec, -1
    v_mov_b32_dpp v21, v18 row_newbcast:7 row_mask:0xf bank_mask:0x3
    s_nop 1
    v_mov_b32_dpp v21, v18 row_newbcast:15 row_mask:0xf bank_mask:0xc
    v_and_b32 v116, v21, v12
    v_and_b32 v117, v21, v13
    v_and_b32 v118, v21, v14
    v_and_b32 v119, v21, v15
    s_nop 1
    v_mfma_f32_16x16x32_bf16 v[124:127], v[116:119], v[32:35], v[124:127]
    s_waitcnt vmcnt(3)
    s_cmp_gt_u32 s63, 1
    s_cbranch_scc1 Llv_31
    s_waitcnt vmcnt(2)
Llv_31:
    s_movk_i32 s15, 24576
    buffer_load_dwordx4 v[32:35], v30, s[52:55], s15 offen nt
    s_mov_b32 m0, s61
    s_mov_b32 exec_lo, 0
    buffer_load_dwordx4 v6, s[56:59], s62 offen lds
    s_mov_b64 exec, -1
    s_add_u32 s61, s61, 4096
    s_add_u32 s62, s62, 589824
    v_mov_b32_dpp v20, v19 row_newbcast:0 row_mask:0xf bank_mask:0x3
    s_nop 1
    v_mov_b32_dpp v20, v19 row_newbcast:8 row_mask:0xf bank_mask:0xc
    v_and_b32 v112, v20, v12
    v_and_b32 v113, v20, v13
    v_and_b32 v114, v20, v14
    v_and_b32 v115, v20, v15
    s_nop 1
    v_mfma_f32_16x16x32_bf16 v[124:127], v[112:115], v[36:39], v[124:127]
    s_waitcnt vmcnt(3)
    s_cmp_gt_u32 s63, 5
    s_cbranch_scc1 Llv_32
    s_waitcnt vmcnt(2)
Llv_32:
    s_movk_i32 s15, 26624
    buffer_load_dwordx4 v[36:39], v30, s[52:55], s15 offen nt
    v_mov_b32_dpp v21, v19 row_newbcast:4 row_mask:0xf bank_mask:0x3
    s_nop 1
    v_mov_b32_dpp v21, v19 row_newbcast:12 row_mask:0xf bank_mask:0xc
    v_and_b32 v116, v21, v12
    v_and_b32 v117, v21, v13
    v_and_b32 v118, v21, v14
    v_and_b32 v119, v21, v15
    s_nop 1
    v_mfma_f32_16x16x32_bf16 v[124:127], v[116:119], v[40:43], v[124:127]
    s_waitcnt vmcnt(3)
    s_cmp_gt_u32 s63, 3
    s_cbranch_scc1 Llv_33
    s_waitcnt vmcnt(2)
Llv_33:
    s_movk_i32 s15, 28672
    buffer_load_dwordx4 v[40:43], v30, s[52:55], s15 offen nt
Lsp_34:
    ds_read_b32 v4, v5 offset:7500
    s_waitcnt lgkmcnt(0)
    v_readfirstlane_b32 s11, v4
    s_cmp_lg_u32 s11, 0
    s_cbranch_scc1 Lspd_35
    s_sleep 1
    s_sub_u32 s70, s70, 1
    s_cmp_gt_i32 s70, 0
    s_cbranch_scc1 Lsp_34
Lspd_35:
    s_and_b32 s11, s7, 2
    s_lshl_b32 s11, s11, 3
    s_add_u32 s11, s11, s4
    s_lshl_b32 s11, s11, 2
    v_mov_b32 v4, s11
    v_xor_b32 v29, 32, v4
    ds_read_b32 v26, v4 offset:7296
    ds_read_b32 v27, v29 offset:7296
    v_lshrrev_b32 v22, 3, v2
    v_lshrrev_b32 v23, 1, v3
    v_cmp_eq_u32 vcc, v22, v23
    v_and_b32 v23, 7, v1
    v_lshlrev_b32 v23, 5, v23
    v_and_b32 v24, 1, v3
    v_lshl_add_u32 v23, v24, 4, v23
    v_lshl_add_u32 v23, v22, 8, v23
    s_lshl_b32 s11, s4, 9
    s_add_u32 s11, s11, 0
    v_add_u32 v23, s11, v23
    v_lshlrev_b32 v24, 4, v1
    v_add_u32 v24, 10880, v24
    v_cndmask_b32 v23, v24, v23, vcc
    s_waitcnt lgkmcnt(0)
    v_mov_b32_dpp v20, v19 row_newbcast:2 row_mask:0xf bank_mask:0x3
    s_nop 1
    v_mov_b32_dpp v20, v19 row_newbcast:10 row_mask:0xf bank_mask:0xc
    v_and_b32 v112, v20, v12
    v_and_b32 v113, v20, v13
    v_and_b32 v114, v20, v14
    v_and_b32 v115, v20, v15
    s_nop 1
    v_mfma_f32_16x16x32_bf16 v[124:127], v[112:115], v[44:47], v[124:127]
    s_waitcnt vmcnt(3)
    s_cmp_gt_u32 s63, 7
    s_cbranch_scc1 Llv_36
    s_waitcnt vmcnt(2)
Llv_36:
    s_movk_i32 s15, 30720
    buffer_load_dwordx4 v[44:47], v30, s[52:55], s15 offen nt
    v_mov_b32_dpp v21, v19 row_newbcast:6 row_mask:0xf bank_mask:0x3
    s_nop 1
    v_mov_b32_dpp v21, v19 row_newbcast:14 row_mask:0xf bank_mask:0xc
    v_and_b32 v116, v21, v12
    v_and_b32 v117, v21, v13
    v_and_b32 v118, v21, v14
    v_and_b32 v119, v21, v15
    s_nop 1
    v_mfma_f32_16x16x32_bf16 v[124:127], v[116:119], v[48:51], v[124:127]
    v_mov_b32_dpp v20, v19 row_newbcast:1 row_mask:0xf bank_mask:0x3
    s_nop 1
    v_mov_b32_dpp v20, v19 row_newbcast:9 row_mask:0xf bank_mask:0xc
    v_and_b32 v112, v20, v12
    v_and_b32 v113, v20, v13
    v_and_b32 v114, v20, v14
    v_and_b32 v115, v20, v15
    s_nop 1
    v_mfma_f32_16x16x32_bf16 v[124:127], v[112:115], v[32:35], v[124:127]
    v_mov_b32_dpp v21, v19 row_newbcast:5 row_mask:0xf bank_mask:0x3
    s_nop 1
    v_mov_b32_dpp v21, v19 row_newbcast:13 row_mask:0xf bank_mask:0xc
    v_and_b32 v116, v21, v12
    v_and_b32 v117, v21, v13
    v_and_b32 v118, v21, v14
    v_and_b32 v119, v21, v15
    s_waitcnt vmcnt(2)
    s_nop 0
    v_mfma_f32_16x16x32_bf16 v[124:127], v[116:119], v[36:39], v[124:127]
    v_mov_b32_dpp v20, v19 row_newbcast:3 row_mask:0xf bank_mask:0x3
    s_nop 1
    v_mov_b32_dpp v20, v19 row_newbcast:11 row_mask:0xf bank_mask:0xc
    v_and_b32 v112, v20, v12
    v_and_b32 v113, v20, v13
    v_and_b32 v114, v20, v14
    v_and_b32 v115, v20, v15
    s_waitcnt vmcnt(1)
    s_nop 0
    v_mfma_f32_16x16x32_bf16 v[124:127], v[112:115], v[40:43], v[124:127]
    v_mov_b32_dpp v21, v19 row_newbcast:7 row_mask:0xf bank_mask:0x3
    s_nop 1
    v_mov_b32_dpp v21, v19 row_newbcast:15 row_mask:0xf bank_mask:0xc
    v_and_b32 v116, v21, v12
    v_and_b32 v117, v21, v13
    v_and_b32 v118, v21, v14
    v_and_b32 v119, v21, v15
    s_waitcnt vmcnt(0)
    s_nop 0
    v_mfma_f32_16x16x32_bf16 v[124:127], v[116:119], v[44:47], v[124:127]
    s_cmp_gt_u32 s63, 0
    s_cbranch_scc1 Llv_37
    s_waitcnt vmcnt(4)
Llv_37:
    v_mul_f32 v120, v26, v120
    v_mul_f32 v121, v26, v121
    v_mul_f32 v122, v26, v122
    v_mul_f32 v123, v26, v123
    s_nop 0
    v_fmac_f32 v120, v27, v124
    v_fmac_f32 v121, v27, v125
    v_fmac_f32 v122, v27, v126
    v_fmac_f32 v123, v27, v127
    ds_write_b128 v23, v[120:123]
    s_waitcnt lgkmcnt(0)
    s_barrier
    s_endpgm
Lhelper:
    v_mov_b32 v104, 1073741824
    v_mov_b32 v105, 1073741824
    v_mov_b32 v106, 1073741824
    v_mov_b32 v107, 1073741824
    v_mov_b32 v108, 1073741824
    v_mov_b32 v109, 1073741824
    v_mov_b32 v110, 1073741824
    v_mov_b32 v111, 1073741824
    s_mul_i32 s68, s9, 9
    s_add_u32 s68, s68, s8
    s_sub_u32 s68, s68, 18
    s_mov_b32 s69, 0
    s_cmp_lt_u32 s8, 27
    s_cselect_b32 s69, 2, 0
    s_cmp_lt_u32 s8, 18
    s_cselect_b32 s69, 1, s69
    s_cmp_ge_u32 s68, 36
    s_cselect_b32 s71, 1, 0
    s_cmp_eq_u32 s4, 1
    s_cbranch_scc1 Lw1
    s_cmp_eq_u32 s4, 2
    s_cbranch_scc1 Lw2
    s_cmp_eq_u32 s4, 3
    s_cbranch_scc1 Lw3
    v_mov_b32 v6, 0
    v_mov_b32 v7, 0
    v_mov_b32 v8, 0
    v_mov_b32 v9, 0
    ds_write_b128 v5, v[6:9] offset:7488
    s_waitcnt lgkmcnt(0)
    s_add_u32 s97, s97, 1
    s_and_b32 s99, s97, s96
    v_mov_b32 v0, s99
    s_barrier
    s_branch Lbulk
Lw1:
    s_mov_b32 s48, s36
    s_and_b32 s49, s37, 0xffff
    s_mov_b32 s50, 3981312
    s_mov_b32 s51, 0x20000
    s_mov_b32 s52, s34
    s_and_b32 s53, s35, 0xffff
    s_mov_b32 s54, 2304
    s_mov_b32 s55, 0x20000
    s_mov_b32 s60, s16
    s_and_b32 s61, s17, 0xffff
    s_mov_b32 s62, 2304
    s_mov_b32 s63, 0x20000
    s_mul_i32 s11, s3, 7282
    s_lshr_b32 s11, s11, 16
    s_mul_i32 s12, s11, 9
    s_sub_u32 s12, s3, s12
    s_cmp_lt_u32 s3, 243
    s_cbranch_scc1 Lw1a
    s_waitcnt lgkmcnt(0)
    s_add_u32 s97, s97, 1
    s_and_b32 s99, s97, s96
    v_mov_b32 v0, s99
    s_barrier
    s_branch Lw1clr
Lw1a:
    s_lshl_b32 s13, s12, 6
    v_lshl_add_u32 v6, v2, 2, v3
    v_add_u32 v6, s13, v6
    v_lshlrev_b32 v6, 1, v6
    buffer_load_ushort v16, v6, s[52:55], 0 offen
    buffer_load_ushort v17, v6, s[52:55], 0 offen offset:1152
    v_add_u32 v6, s13, v3
    v_mul_u32_u24 v6, 6912, v6
    s_lshl_b32 s14, s11, 8
    v_lshl_add_u32 v6, v2, 4, v6
    v_add_u32 v6, s14, v6
    s_mov_b32 s15, 0
    buffer_load_dwordx4 v[32:35], v6, s[48:51], s15 offen nt
    s_mov_b32 s15, 27648
    buffer_load_dwordx4 v[36:39], v6, s[48:51], s15 offen nt
    s_mov_b32 s15, 55296
    buffer_load_dwordx4 v[40:43], v6, s[48:51], s15 offen nt
    s_mov_b32 s15, 82944
    buffer_load_dwordx4 v[44:47], v6, s[48:51], s15 offen nt
    s_mov_b32 s15, 110592
    buffer_load_dwordx4 v[48:51], v6, s[48:51], s15 offen nt
    s_mov_b32 s15, 138240
    buffer_load_dwordx4 v[52:55], v6, s[48:51], s15 offen nt
    s_mov_b32 s15, 165888
    buffer_load_dwordx4 v[56:59], v6, s[48:51], s15 offen nt
    s_mov_b32 s15, 193536
    buffer_load_dwordx4 v[60:63], v6, s[48:51], s15 offen nt
    s_mov_b32 s15, 221184
    buffer_load_dwordx4 v[64:67], v6, s[48:51], s15 offen nt
    s_mov_b32 s15, 248832
    buffer_load_dwordx4 v[68:71], v6, s[48:51], s15 offen nt
    s_mov_b32 s15, 276480
    buffer_load_dwordx4 v[72:75], v6, s[48:51], s15 offen nt
    s_mov_b32 s15, 304128
    buffer_load_dwordx4 v[76:79], v6, s[48:51], s15 offen nt
    s_mov_b32 s15, 331776
    buffer_load_dwordx4 v[80:83], v6, s[48:51], s15 offen nt
    s_mov_b32 s15, 359424
    buffer_load_dwordx4 v[84:87], v6, s[48:51], s15 offen nt
    s_mov_b32 s15, 387072
    buffer_load_dwordx4 v[88:91], v6, s[48:51], s15 offen nt
    s_mov_b32 s15, 414720
    buffer_load_dwordx4 v[92:95], v6, s[48:51], s15 offen nt
    s_barrier
    s_waitcnt lgkmcnt(0)
    s_add_u32 s97, s97, 1
    s_and_b32 s99, s97, s96
    v_mov_b32 v0, s99
    s_waitcnt vmcnt(16)
    v_lshlrev_b32 v16, 16, v16
    v_mul_f32 v18, 0xbfb8aa3b, v16
    v_exp_f32 v18, v18
    s_nop 0
    v_add_f32 v18, 1.0, v18
    v_rcp_f32 v18, v18
    s_nop 0
    v_mul_f32 v16, v16, v18
    v_cvt_pk_bf16_f32 v16, v16, v16
    v_lshlrev_b32 v17, 16, v17
    v_mul_f32 v18, 0xbfb8aa3b, v17
    v_exp_f32 v18, v18
    s_nop 0
    v_add_f32 v18, 1.0, v18
    v_rcp_f32 v18, v18
    s_nop 0
    v_mul_f32 v17, v17, v18
    v_cvt_pk_bf16_f32 v17, v17, v17
    v_mov_b32_dpp v20, v16 row_newbcast:0 row_mask:0xf bank_mask:0x3
    s_nop 1
    v_mov_b32_dpp v20, v17 row_newbcast:0 row_mask:0xf bank_mask:0xc
    v_and_b32 v112, v20, v12
    v_and_b32 v113, v20, v13
    v_and_b32 v114, v20, v14
    v_and_b32 v115, v20, v15
    s_waitcnt vmcnt(15)
    s_nop 0
    v_mfma_f32_16x16x32_bf16 v[120:123], v[112:115], v[32:35], 0
    v_mov_b32_dpp v21, v16 row_newbcast:1 row_mask:0xf bank_mask:0x3
    s_nop 1
    v_mov_b32_dpp v21, v17 row_newbcast:1 row_mask:0xf bank_mask:0xc
    v_and_b32 v116, v21, v12
    v_and_b32 v117, v21, v13
    v_and_b32 v118, v21, v14
    v_and_b32 v119, v21, v15
    s_waitcnt vmcnt(14)
    s_nop 0
    v_mfma_f32_16x16x32_bf16 v[120:123], v[116:119], v[36:39], v[120:123]
    v_mov_b32_dpp v20, v16 row_newbcast:2 row_mask:0xf bank_mask:0x3
    s_nop 1
    v_mov_b32_dpp v20, v17 row_newbcast:2 row_mask:0xf bank_mask:0xc
    v_and_b32 v112, v20, v12
    v_and_b32 v113, v20, v13
    v_and_b32 v114, v20, v14
    v_and_b32 v115, v20, v15
    s_waitcnt vmcnt(13)
    s_nop 0
    v_mfma_f32_16x16x32_bf16 v[120:123], v[112:115], v[40:43], v[120:123]
    v_mov_b32_dpp v21, v16 row_newbcast:3 row_mask:0xf bank_mask:0x3
    s_nop 1
    v_mov_b32_dpp v21, v17 row_newbcast:3 row_mask:0xf bank_mask:0xc
    v_and_b32 v116, v21, v12
    v_and_b32 v117, v21, v13
    v_and_b32 v118, v21, v14
    v_and_b32 v119, v21, v15
    s_waitcnt vmcnt(12)
    s_nop 0
    v_mfma_f32_16x16x32_bf16 v[120:123], v[116:119], v[44:47], v[120:123]
    v_mov_b32_dpp v20, v16 row_newbcast:4 row_mask:0xf bank_mask:0x3
    s_nop 1
    v_mov_b32_dpp v20, v17 row_newbcast:4 row_mask:0xf bank_mask:0xc
    v_and_b32 v112, v20, v12
    v_and_b32 v113, v20, v13
    v_and_b32 v114, v20, v14
    v_and_b32 v115, v20, v15
    s_waitcnt vmcnt(11)
    s_nop 0
    v_mfma_f32_16x16x32_bf16 v[120:123], v[112:115], v[48:51], v[120:123]
    v_mov_b32_dpp v21, v16 row_newbcast:5 row_mask:0xf bank_mask:0x3
    s_nop 1
    v_mov_b32_dpp v21, v17 row_newbcast:5 row_mask:0xf bank_mask:0xc
    v_and_b32 v116, v21, v12
    v_and_b32 v117, v21, v13
    v_and_b32 v118, v21, v14
    v_and_b32 v119, v21, v15
    s_waitcnt vmcnt(10)
    s_nop 0
    v_mfma_f32_16x16x32_bf16 v[120:123], v[116:119], v[52:55], v[120:123]
    v_mov_b32_dpp v20, v16 row_newbcast:6 row_mask:0xf bank_mask:0x3
    s_nop 1
    v_mov_b32_dpp v20, v17 row_newbcast:6 row_mask:0xf bank_mask:0xc
    v_and_b32 v112, v20, v12
    v_and_b32 v113, v20, v13
    v_and_b32 v114, v20, v14
    v_and_b32 v115, v20, v15
    s_waitcnt vmcnt(9)
    s_nop 0
    v_mfma_f32_16x16x32_bf16 v[120:123], v[112:115], v[56:59], v[120:123]
    v_mov_b32_dpp v21, v16 row_newbcast:7 row_mask:0xf bank_mask:0x3
    s_nop 1
    v_mov_b32_dpp v21, v17 row_newbcast:7 row_mask:0xf bank_mask:0xc
    v_and_b32 v116, v21, v12
    v_and_b32 v117, v21, v13
    v_and_b32 v118, v21, v14
    v_and_b32 v119, v21, v15
    s_waitcnt vmcnt(8)
    s_nop 0
    v_mfma_f32_16x16x32_bf16 v[120:123], v[116:119], v[60:63], v[120:123]
    v_mov_b32_dpp v20, v16 row_newbcast:8 row_mask:0xf bank_mask:0x3
    s_nop 1
    v_mov_b32_dpp v20, v17 row_newbcast:8 row_mask:0xf bank_mask:0xc
    v_and_b32 v112, v20, v12
    v_and_b32 v113, v20, v13
    v_and_b32 v114, v20, v14
    v_and_b32 v115, v20, v15
    s_waitcnt vmcnt(7)
    s_nop 0
    v_mfma_f32_16x16x32_bf16 v[120:123], v[112:115], v[64:67], v[120:123]
    v_mov_b32_dpp v21, v16 row_newbcast:9 row_mask:0xf bank_mask:0x3
    s_nop 1
    v_mov_b32_dpp v21, v17 row_newbcast:9 row_mask:0xf bank_mask:0xc
    v_and_b32 v116, v21, v12
    v_and_b32 v117, v21, v13
    v_and_b32 v118, v21, v14
    v_and_b32 v119, v21, v15
    s_waitcnt vmcnt(6)
    s_nop 0
    v_mfma_f32_16x16x32_bf16 v[120:123], v[116:119], v[68:71], v[120:123]
    v_mov_b32_dpp v20, v16 row_newbcast:10 row_mask:0xf bank_mask:0x3
    s_nop 1
    v_mov_b32_dpp v20, v17 row_newbcast:10 row_mask:0xf bank_mask:0xc
    v_and_b32 v112, v20, v12
    v_and_b32 v113, v20, v13
    v_and_b32 v114, v20, v14
    v_and_b32 v115, v20, v15
    s_waitcnt vmcnt(5)
    s_nop 0
    v_mfma_f32_16x16x32_bf16 v[120:123], v[112:115], v[72:75], v[120:123]
    v_mov_b32_dpp v21, v16 row_newbcast:11 row_mask:0xf bank_mask:0x3
    s_nop 1
    v_mov_b32_dpp v21, v17 row_newbcast:11 row_mask:0xf bank_mask:0xc
    v_and_b32 v116, v21, v12
    v_and_b32 v117, v21, v13
    v_and_b32 v118, v21, v14
    v_and_b32 v119, v21, v15
    s_waitcnt vmcnt(4)
    s_nop 0
    v_mfma_f32_16x16x32_bf16 v[120:123], v[116:119], v[76:79], v[120:123]
    v_mov_b32_dpp v20, v16 row_newbcast:12 row_mask:0xf bank_mask:0x3
    s_nop 1
    v_mov_b32_dpp v20, v17 row_newbcast:12 row_mask:0xf bank_mask:0xc
    v_and_b32 v112, v20, v12
    v_and_b32 v113, v20, v13
    v_and_b32 v114, v20, v14
    v_and_b32 v115, v20, v15
    s_waitcnt vmcnt(3)
    s_nop 0
    v_mfma_f32_16x16x32_bf16 v[120:123], v[112:115], v[80:83], v[120:123]
    v_mov_b32_dpp v21, v16 row_newbcast:13 row_mask:0xf bank_mask:0x3
    s_nop 1
    v_mov_b32_dpp v21, v17 row_newbcast:13 row_mask:0xf bank_mask:0xc
    v_and_b32 v116, v21, v12
    v_and_b32 v117, v21, v13
    v_and_b32 v118, v21, v14
    v_and_b32 v119, v21, v15
    s_waitcnt vmcnt(2)
    s_nop 0
    v_mfma_f32_16x16x32_bf16 v[120:123], v[116:119], v[84:87], v[120:123]
    v_mov_b32_dpp v20, v16 row_newbcast:14 row_mask:0xf bank_mask:0x3
    s_nop 1
    v_mov_b32_dpp v20, v17 row_newbcast:14 row_mask:0xf bank_mask:0xc
    v_and_b32 v112, v20, v12
    v_and_b32 v113, v20, v13
    v_and_b32 v114, v20, v14
    v_and_b32 v115, v20, v15
    s_waitcnt vmcnt(1)
    s_nop 0
    v_mfma_f32_16x16x32_bf16 v[120:123], v[112:115], v[88:91], v[120:123]
    v_mov_b32_dpp v21, v16 row_newbcast:15 row_mask:0xf bank_mask:0x3
    s_nop 1
    v_mov_b32_dpp v21, v17 row_newbcast:15 row_mask:0xf bank_mask:0xc
    v_and_b32 v116, v21, v12
    v_and_b32 v117, v21, v13
    v_and_b32 v118, v21, v14
    v_and_b32 v119, v21, v15
    s_waitcnt vmcnt(0)
    s_nop 0
    v_mfma_f32_16x16x32_bf16 v[120:123], v[116:119], v[92:95], v[120:123]
    v_lshrrev_b32 v6, 1, v3
    v_mul_u32_u24 v6, 13824, v6
    v_and_b32 v7, 1, v3
    v_lshl_add_u32 v6, v7, 4, v6
    v_lshl_add_u32 v6, v2, 5, v6
    s_mul_i32 s13, s12, 27648
    s_lshl_b32 s14, s11, 9
    s_add_u32 s13, s13, s14
    s_add_u32 s13, s13, 2097152
    v_add_u32 v120, 0x200, v120
    v_add_u32 v121, 0x200, v121
    v_add_u32 v122, 0x200, v122
    v_add_u32 v123, 0x200, v123
    v_bfi_b32 v120, s96, v0, v120
    v_bfi_b32 v121, s96, v0, v121
    v_bfi_b32 v122, s96, v0, v122
    v_bfi_b32 v123, s96, v0, v123
    buffer_store_dwordx4 v[120:123], v6, s[44:47], s13 offen sc1
    s_waitcnt vmcnt(0)
Lw1clr:
    s_waitcnt lgkmcnt(0)
    v_mov_b32 v4, 1
    ds_write_b32 v5, v4 offset:7496
    s_cmp_lg_u32 s69, 2
    s_cbranch_scc1 Lbulk
Lsp_38:
    ds_read_b32 v4, v5 offset:7492
    s_waitcnt lgkmcnt(0)
    v_readfirstlane_b32 s11, v4
    s_cmp_lg_u32 s11, 0
    s_cbranch_scc1 Lspd_39
    s_sleep 1
    s_sub_u32 s70, s70, 1
    s_cmp_gt_i32 s70, 0
    s_cbranch_scc1 Lsp_38
Lspd_39:
    s_mul_i32 s12, s71, 36
    s_sub_u32 s12, s68, s12
    s_lshl_b32 s12, s12, 4
    v_mul_u32_u24 v6, 576, v3
    v_add3_u32 v6, v6, v2, s12
    v_lshlrev_b32 v6, 2, v6
    s_mul_i32 s13, s71, 13824
    s_add_u32 s13, s13, 2101760
    s_mul_i32 s14, s71, 576
    s_add_u32 s14, s14, s12
    v_add_u32 v7, s14, v2
    v_lshlrev_b32 v8, 1, v7
    buffer_load_ushort v107, v8, s[60:63], 0 offen
Lpo_40:
    s_add_u32 s14, s13, 0
    buffer_load_dword v32, v6, s[44:47], s14 offen sc1
    s_add_u32 s14, s13, 27648
    buffer_load_dword v33, v6, s[44:47], s14 offen sc1
    s_add_u32 s14, s13, 55296
    buffer_load_dword v34, v6, s[44:47], s14 offen sc1
    s_add_u32 s14, s13, 82944
    buffer_load_dword v35, v6, s[44:47], s14 offen sc1
    s_add_u32 s14, s13, 110592
    buffer_load_dword v36, v6, s[44:47], s14 offen sc1
    s_add_u32 s14, s13, 138240
    buffer_load_dword v37, v6, s[44:47], s14 offen sc1
    s_add_u32 s14, s13, 165888
    buffer_load_dword v38, v6, s[44:47], s14 offen sc1
    s_add_u32 s14, s13, 193536
    buffer_load_dword v39, v6, s[44:47], s14 offen sc1
    s_add_u32 s14, s13, 221184
    buffer_load_dword v40, v6, s[44:47], s14 offen sc1
    s_waitcnt vmcnt(0)
Lpoc_42:
    v_xor_b32 v9, v32, v0
    v_bitop3_b32 v9, v9, v33, v0 bitop3:0xf6
    v_bitop3_b32 v9, v9, v34, v0 bitop3:0xf6
    v_bitop3_b32 v9, v9, v35, v0 bitop3:0xf6
    v_bitop3_b32 v9, v9, v36, v0 bitop3:0xf6
    v_bitop3_b32 v9, v9, v37, v0 bitop3:0xf6
    v_bitop3_b32 v9, v9, v38, v0 bitop3:0xf6
    v_bitop3_b32 v9, v9, v39, v0 bitop3:0xf6
    v_bitop3_b32 v9, v9, v40, v0 bitop3:0xf6
    v_and_b32 v9, s96, v9
    v_cmp_ne_u32 vcc, 0, v9
    s_cbranch_vccz Lpod_41
    s_sleep 8
    s_sub_u32 s70, s70, 1
    s_cmp_gt_i32 s70, 0
    s_cbranch_scc1 Lpo_40
Lpod_41:
    v_and_b32 v32, s98, v32
    v_and_b32 v33, s98, v33
    v_and_b32 v34, s98, v34
    v_and_b32 v35, s98, v35
    v_and_b32 v36, s98, v36
    v_and_b32 v37, s98, v37
    v_and_b32 v38, s98, v38
    v_and_b32 v39, s98, v39
    v_and_b32 v40, s98, v40
    v_add_f32 v32, v32, v33
    v_add_f32 v32, v32, v34
    v_add_f32 v32, v32, v35
    v_add_f32 v32, v32, v36
    v_add_f32 v32, v32, v37
    v_add_f32 v32, v32, v38
    v_add_f32 v32, v32, v39
    v_add_f32 v32, v32, v40
    v_cvt_pk_bf16_f32 v32, v32, v32
    v_and_b32 v32, 0xffff0000, v32
    v_add_f32 v33, 1.0, v32
    v_cvt_pk_bf16_f32 v33, v33, v33
    v_and_b32 v33, 0xffff0000, v33
    v_cmp_eq_u32 vcc, 2, v3
    s_nop 1
    v_cndmask_b32 v32, v32, v33, vcc
    v_mov_b32 v9, 1073741824
    v_mov_b32 v10, 2056192
    v_cndmask_b32 v9, v9, v10, vcc
    v_cmp_eq_u32 vcc, 1, v3
    v_mov_b32 v10, 2060800
    s_nop 0
    v_cndmask_b32 v9, v9, v10, vcc
    v_lshl_add_u32 v9, v7, 2, v9
    v_or_b32 v33, v32, v0
    buffer_store_dword v33, v9, s[44:47], 0 offen sc1
    v_lshlrev_b32 v10, 2, v2
    v_add_u32 v11, 192, v10
    ds_bpermute_b32 v108, v10, v32
    ds_bpermute_b32 v109, v11, v32
    v_lshlrev_b32 v107, 16, v107
    v_cmp_gt_u32 vcc, 16, v1
    v_mov_b32 v9, 1073741824
    s_nop 0
    v_cndmask_b32 v110, v9, v8, vcc
    v_mul_u32_u24 v111, 4608, v3
    v_add_u32 v111, v111, v10
    s_waitcnt lgkmcnt(0)
    s_branch Lbulk
Lw2:
    s_mov_b32 s48, s22
    s_and_b32 s49, s23, 0xffff
    s_mov_b32 s50, 4718592
    s_mov_b32 s51, 0x20000
    s_mov_b32 s11, s9
    s_mul_i32 s11, s11, 72
    v_add_u32 v6, s11, v3
    v_lshlrev_b32 v6, 13, v6
    s_lshl_b32 s12, s8, 8
    v_lshl_add_u32 v6, v2, 4, v6
    v_add_u32 v6, s12, v6
    s_mov_b32 s15, 0
    buffer_load_dwordx4 v[32:35], v6, s[48:51], s15 offen nt
    s_mov_b32 s15, 32768
    buffer_load_dwordx4 v[36:39], v6, s[48:51], s15 offen nt
    s_mov_b32 s15, 65536
    buffer_load_dwordx4 v[40:43], v6, s[48:51], s15 offen nt
    s_mov_b32 s15, 98304
    buffer_load_dwordx4 v[44:47], v6, s[48:51], s15 offen nt
    s_mov_b32 s15, 131072
    buffer_load_dwordx4 v[48:51], v6, s[48:51], s15 offen nt
    s_mov_b32 s15, 163840
    buffer_load_dwordx4 v[52:55], v6, s[48:51], s15 offen nt
    s_mov_b32 s15, 196608
    buffer_load_dwordx4 v[56:59], v6, s[48:51], s15 offen nt
    s_mov_b32 s15, 229376
    buffer_load_dwordx4 v[60:63], v6, s[48:51], s15 offen nt
    s_mov_b32 s15, 262144
    buffer_load_dwordx4 v[64:67], v6, s[48:51], s15 offen nt
    s_mov_b32 s15, 294912
    buffer_load_dwordx4 v[68:71], v6, s[48:51], s15 offen nt
    s_mov_b32 s15, 327680
    buffer_load_dwordx4 v[72:75], v6, s[48:51], s15 offen nt
    s_mov_b32 s15, 360448
    buffer_load_dwordx4 v[76:79], v6, s[48:51], s15 offen nt
    s_mov_b32 s15, 393216
    buffer_load_dwordx4 v[80:83], v6, s[48:51], s15 offen nt
    s_mov_b32 s15, 425984
    buffer_load_dwordx4 v[84:87], v6, s[48:51], s15 offen nt
    s_mov_b32 s15, 458752
    buffer_load_dwordx4 v[88:91], v6, s[48:51], s15 offen nt
    s_mov_b32 s15, 491520
    buffer_load_dwordx4 v[92:95], v6, s[48:51], s15 offen nt
    s_mov_b32 s15, 524288
    buffer_load_dwordx4 v[96:99], v6, s[48:51], s15 offen nt
    s_mov_b32 s15, 557056
    buffer_load_dwordx4 v[100:103], v6, s[48:51], s15 offen nt
    s_barrier
    v_lshrrev_b32 v6, 3, v2
    v_lshl_add_u32 v6, v6, 2, v3
    v_mul_u32_u24 v6, 80, v6
    s_waitcnt lgkmcnt(0)
    s_add_u32 s97, s97, 1
    s_and_b32 s99, s97, s96
    v_mov_b32 v0, s99
Lsp_43:
    ds_read_b32 v4, v5 offset:7492
    s_waitcnt lgkmcnt(0)
    v_readfirstlane_b32 s11, v4
    s_cmp_lg_u32 s11, 0
    s_cbranch_scc1 Lspd_44
    s_sleep 1
    s_sub_u32 s70, s70, 1
    s_cmp_gt_i32 s70, 0
    s_cbranch_scc1 Lsp_43
Lspd_44:
    ds_read_b128 v[16:19], v6 offset:6400
    ds_read_b128 v[20:23], v6 offset:6416
    ds_read_b128 v[24:27], v6 offset:6432
    ds_read_b128 v[104:107], v6 offset:6448
    ds_read_b128 v[108:111], v6 offset:6464
    s_waitcnt vmcnt(0) lgkmcnt(0)
    v_and_b32 v112, v16, v12
    v_and_b32 v113, v16, v13
    v_and_b32 v114, v16, v14
    v_and_b32 v115, v16, v15
    s_nop 1
    v_mfma_f32_16x16x32_bf16 v[120:123], v[112:115], v[32:35], 0
    v_and_b32 v116, v17, v12
    v_and_b32 v117, v17, v13
    v_and_b32 v118, v17, v14
    v_and_b32 v119, v17, v15
    s_nop 1
    v_mfma_f32_16x16x32_bf16 v[120:123], v[116:119], v[36:39], v[120:123]
    v_and_b32 v112, v18, v12
    v_and_b32 v113, v18, v13
    v_and_b32 v114, v18, v14
    v_and_b32 v115, v18, v15
    s_nop 1
    v_mfma_f32_16x16x32_bf16 v[120:123], v[112:115], v[40:43], v[120:123]
    v_and_b32 v116, v19, v12
    v_and_b32 v117, v19, v13
    v_and_b32 v118, v19, v14
    v_and_b32 v119, v19, v15
    s_nop 1
    v_mfma_f32_16x16x32_bf16 v[120:123], v[116:119], v[44:47], v[120:123]
    v_and_b32 v112, v20, v12
    v_and_b32 v113, v20, v13
    v_and_b32 v114, v20, v14
    v_and_b32 v115, v20, v15
    s_nop 1
    v_mfma_f32_16x16x32_bf16 v[120:123], v[112:115], v[48:51], v[120:123]
    v_and_b32 v116, v21, v12
    v_and_b32 v117, v21, v13
    v_and_b32 v118, v21, v14
    v_and_b32 v119, v21, v15
    s_nop 1
    v_mfma_f32_16x16x32_bf16 v[120:123], v[116:119], v[52:55], v[120:123]
    v_and_b32 v112, v22, v12
    v_and_b32 v113, v22, v13
    v_and_b32 v114, v22, v14
    v_and_b32 v115, v22, v15
    s_nop 1
    v_mfma_f32_16x16x32_bf16 v[120:123], v[112:115], v[56:59], v[120:123]
    v_and_b32 v116, v23, v12
    v_and_b32 v117, v23, v13
    v_and_b32 v118, v23, v14
    v_and_b32 v119, v23, v15
    s_nop 1
    v_mfma_f32_16x16x32_bf16 v[120:123], v[116:119], v[60:63], v[120:123]
    v_and_b32 v112, v24, v12
    v_and_b32 v113, v24, v13
    v_and_b32 v114, v24, v14
    v_and_b32 v115, v24, v15
    s_nop 1
    v_mfma_f32_16x16x32_bf16 v[120:123], v[112:115], v[64:67], v[120:123]
    v_and_b32 v116, v25, v12
    v_and_b32 v117, v25, v13
    v_and_b32 v118, v25, v14
    v_and_b32 v119, v25, v15
    s_nop 1
    v_mfma_f32_16x16x32_bf16 v[120:123], v[116:119], v[68:71], v[120:123]
    v_and_b32 v112, v26, v12
    v_and_b32 v113, v26, v13
    v_and_b32 v114, v26, v14
    v_and_b32 v115, v26, v15
    s_nop 1
    v_mfma_f32_16x16x32_bf16 v[120:123], v[112:115], v[72:75], v[120:123]
    v_and_b32 v116, v27, v12
    v_and_b32 v117, v27, v13
    v_and_b32 v118, v27, v14
    v_and_b32 v119, v27, v15
    s_nop 1
    v_mfma_f32_16x16x32_bf16 v[120:123], v[116:119], v[76:79], v[120:123]
    v_and_b32 v112, v104, v12
    v_and_b32 v113, v104, v13
    v_and_b32 v114, v104, v14
    v_and_b32 v115, v104, v15
    s_nop 1
    v_mfma_f32_16x16x32_bf16 v[120:123], v[112:115], v[80:83], v[120:123]
    v_and_b32 v116, v105, v12
    v_and_b32 v117, v105, v13
    v_and_b32 v118, v105, v14
    v_and_b32 v119, v105, v15
    s_nop 1
    v_mfma_f32_16x16x32_bf16 v[120:123], v[116:119], v[84:87], v[120:123]
    v_and_b32 v112, v106, v12
    v_and_b32 v113, v106, v13
    v_and_b32 v114, v106, v14
    v_and_b32 v115, v106, v15
    s_nop 1
    v_mfma_f32_16x16x32_bf16 v[120:123], v[112:115], v[88:91], v[120:123]
    v_and_b32 v116, v107, v12
    v_and_b32 v117, v107, v13
    v_and_b32 v118, v107, v14
    v_and_b32 v119, v107, v15
    s_nop 1
    v_mfma_f32_16x16x32_bf16 v[120:123], v[116:119], v[92:95], v[120:123]
    v_and_b32 v112, v108, v12
    v_and_b32 v113, v108, v13
    v_and_b32 v114, v108, v14
    v_and_b32 v115, v108, v15
    s_nop 1
    v_mfma_f32_16x16x32_bf16 v[120:123], v[112:115], v[96:99], v[120:123]
    v_and_b32 v116, v109, v12
    v_and_b32 v117, v109, v13
    v_and_b32 v118, v109, v14
    v_and_b32 v119, v109, v15
    s_nop 1
    v_mfma_f32_16x16x32_bf16 v[120:123], v[116:119], v[100:103], v[120:123]
    v_lshrrev_b32 v6, 1, v3
    v_lshlrev_b32 v6, 9, v6
    v_and_b32 v7, 1, v3
    v_lshl_add_u32 v6, v7, 4, v6
    v_lshl_add_u32 v6, v2, 5, v6
    s_lshl3_add_u32 s13, s8, s9
    s_lshl_b32 s13, s13, 10
    s_nop 0
    v_add_u32 v120, 0x200, v120
    v_add_u32 v121, 0x200, v121
    v_add_u32 v122, 0x200, v122
    v_add_u32 v123, 0x200, v123
    v_bfi_b32 v120, s96, v0, v120
    v_bfi_b32 v121, s96, v0, v121
    v_bfi_b32 v122, s96, v0, v122
    v_bfi_b32 v123, s96, v0, v123
    buffer_store_dwordx4 v[120:123], v6, s[44:47], s13 offen sc1
    v_lshrrev_b32 v6, 5, v1
    v_lshlrev_b32 v6, 12, v6
    v_and_b32 v7, 31, v1
    v_lshl_add_u32 v6, v7, 4, v6
    s_lshl_b32 s13, s5, 13
    s_lshl_b32 s14, s6, 9
    s_add_u32 s13, s13, s14
Lpx_45:
    buffer_load_dwordx4 v[32:35], v6, s[44:47], s13 offen offset:0 sc1
    buffer_load_dwordx4 v[36:39], v6, s[44:47], s13 offen offset:1024 sc1
    buffer_load_dwordx4 v[40:43], v6, s[44:47], s13 offen offset:2048 sc1
    buffer_load_dwordx4 v[44:47], v6, s[44:47], s13 offen offset:3072 sc1
    s_waitcnt vmcnt(0)
    v_xor_b32 v8, v32, v0
    v_bitop3_b32 v8, v8, v33, v0 bitop3:0xf6
    v_bitop3_b32 v8, v8, v34, v0 bitop3:0xf6
    v_bitop3_b32 v8, v8, v35, v0 bitop3:0xf6
    v_bitop3_b32 v8, v8, v36, v0 bitop3:0xf6
    v_bitop3_b32 v8, v8, v37, v0 bitop3:0xf6
    v_bitop3_b32 v8, v8, v38, v0 bitop3:0xf6
    v_bitop3_b32 v8, v8, v39, v0 bitop3:0xf6
    v_bitop3_b32 v8, v8, v40, v0 bitop3:0xf6
    v_bitop3_b32 v8, v8, v41, v0 bitop3:0xf6
    v_bitop3_b32 v8, v8, v42, v0 bitop3:0xf6
    v_bitop3_b32 v8, v8, v43, v0 bitop3:0xf6
    v_bitop3_b32 v8, v8, v44, v0 bitop3:0xf6
    v_bitop3_b32 v8, v8, v45, v0 bitop3:0xf6
    v_bitop3_b32 v8, v8, v46, v0 bitop3:0xf6
    v_bitop3_b32 v8, v8, v47, v0 bitop3:0xf6
    v_and_b32 v8, s96, v8
    v_cmp_ne_u32 vcc, 0, v8
    s_nop 0
    s_and_b64 exec, vcc, vcc
    s_cbranch_scc0 Lpxd_46
    s_sub_u32 s70, s70, 1
    s_cmp_gt_i32 s70, 0
    s_cbranch_scc1 Lpx_45
Lpxd_46:
    s_mov_b64 exec, -1
    v_and_b32 v32, s98, v32
    v_and_b32 v33, s98, v33
    v_and_b32 v34, s98, v34
    v_and_b32 v35, s98, v35
    v_and_b32 v36, s98, v36
    v_and_b32 v37, s98, v37
    v_and_b32 v38, s98, v38
    v_and_b32 v39, s98, v39
    v_and_b32 v40, s98, v40
    v_and_b32 v41, s98, v41
    v_and_b32 v42, s98, v42
    v_and_b32 v43, s98, v43
    v_and_b32 v44, s98, v44
    v_and_b32 v45, s98, v45
    v_and_b32 v46, s98, v46
    v_and_b32 v47, s98, v47
    v_add_f32 v32, v32, v36
    v_add_f32 v40, v40, v44
    v_add_f32 v33, v33, v37
    v_add_f32 v41, v41, v45
    v_add_f32 v34, v34, v38
    v_add_f32 v42, v42, v46
    v_add_f32 v35, v35, v39
    v_add_f32 v43, v43, v47
    v_add_f32 v32, v32, v40
    v_add_f32 v33, v33, v41
    v_add_f32 v34, v34, v42
    v_add_f32 v35, v35, v43
    v_mov_b32 v36, v32
    v_mov_b32 v37, v33
    v_mov_b32 v38, v34
    v_mov_b32 v39, v35
    v_permlane32_swap_b32 v32, v36
    v_permlane32_swap_b32 v33, v37
    v_permlane32_swap_b32 v34, v38
    v_permlane32_swap_b32 v35, v39
    v_add_f32 v32, v32, v36
    v_add_f32 v33, v33, v37
    v_add_f32 v34, v34, v38
    v_add_f32 v35, v35, v39
    v_cvt_pk_bf16_f32 v32, v32, v33
    v_cvt_pk_bf16_f32 v33, v34, v35
    v_lshlrev_b32 v7, 3, v7
    ds_write_b64 v7, v[32:33] offset:7040
    s_waitcnt lgkmcnt(0)
    v_mov_b32 v4, 1
    ds_write_b32 v5, v4 offset:7488
    s_branch Lbulk
Lw3:
    s_mov_b32 s48, s16
    s_and_b32 s49, s17, 0xffff
    s_mov_b32 s50, 2304
    s_mov_b32 s51, 0x20000
    v_lshrrev_b32 v6, 5, v1
    v_and_b32 v7, 31, v1
    v_mul_u32_u24 v8, 1152, v6
    v_mul_u32_u24 v9, 36, v7
    v_add_u32 v9, v8, v9
    buffer_load_dwordx4 v[32:35], v9, s[48:51], 0 offen
    buffer_load_dwordx4 v[36:39], v9, s[48:51], 0 offen offset:16
    buffer_load_dword v40, v9, s[48:51], 0 offen offset:32
    s_mov_b32 s11, s9
    s_mul_i32 s11, s11, 72
    v_lshl_add_u32 v10, v7, 2, s11
    v_lshl_add_u32 v11, v10, 1, v8
    v_cmp_gt_u32 s[12:13], 18, v7
    v_mov_b32 v9, 1073741824
    s_nop 0
    v_cndmask_b32 v11, v9, v11, s[12:13]
    buffer_load_dwordx2 v[104:105], v11, s[48:51], 0 offen
    s_barrier
    v_mul_u32_u24 v8, 3456, v6
    v_add_lshl_u32 v10, v10, v8, 2
    v_cndmask_b32 v10, v9, v10, s[12:13]
    v_mul_u32_u24 v8, 320, v6
    v_lshl_add_u32 v8, v7, 2, v8
    v_add_u32 v8, 6400, v8
    v_mov_b32 v9, 10880
    v_cndmask_b32 v111, v9, v8, s[12:13]
    s_waitcnt vmcnt(1)
    v_lshlrev_b32 v44, 16, v32
    v_and_b32 v45, 0xffff0000, v32
    v_lshlrev_b32 v46, 16, v33
    v_and_b32 v47, 0xffff0000, v33
    v_lshlrev_b32 v48, 16, v34
    v_and_b32 v49, 0xffff0000, v34
    v_lshlrev_b32 v50, 16, v35
    v_and_b32 v51, 0xffff0000, v35
    v_lshlrev_b32 v52, 16, v36
    v_and_b32 v53, 0xffff0000, v36
    v_lshlrev_b32 v54, 16, v37
    v_and_b32 v55, 0xffff0000, v37
    v_lshlrev_b32 v56, 16, v38
    v_and_b32 v57, 0xffff0000, v38
    v_lshlrev_b32 v58, 16, v39
    v_and_b32 v59, 0xffff0000, v39
    v_lshlrev_b32 v60, 16, v40
    v_and_b32 v61, 0xffff0000, v40
    v_add_f32 v16, v44, v45
    v_add_f32 v16, v16, v46
    v_add_f32 v16, v16, v47
    v_add_f32 v16, v16, v48
    v_add_f32 v16, v16, v49
    v_add_f32 v16, v16, v50
    v_add_f32 v16, v16, v51
    v_add_f32 v16, v16, v52
    v_add_f32 v16, v16, v53
    v_add_f32 v16, v16, v54
    v_add_f32 v16, v16, v55
    v_add_f32 v16, v16, v56
    v_add_f32 v16, v16, v57
    v_add_f32 v16, v16, v58
    v_add_f32 v16, v16, v59
    v_add_f32 v16, v16, v60
    v_add_f32 v16, v16, v61
    s_nop 1
    v_add_f32_dpp v16, v16, v16 row_ror:8 row_mask:0xf bank_mask:0xf
    s_nop 1
    v_add_f32_dpp v16, v16, v16 row_ror:4 row_mask:0xf bank_mask:0xf
    s_nop 1
    v_add_f32_dpp v16, v16, v16 row_ror:2 row_mask:0xf bank_mask:0xf
    s_nop 1
    v_add_f32_dpp v16, v16, v16 row_ror:1 row_mask:0xf bank_mask:0xf
    v_mov_b32 v17, v16
    s_nop 1
    v_permlane16_swap_b32 v16, v17
    v_add_f32 v16, v16, v17
    v_mul_f32 v16, 0x3ae38e39, v16
    v_mov_b32 v17, 0
    v_sub_f32 v18, v44, v16
    v_fmac_f32 v17, v18, v18
    v_sub_f32 v18, v45, v16
    v_fmac_f32 v17, v18, v18
    v_sub_f32 v18, v46, v16
    v_fmac_f32 v17, v18, v18
    v_sub_f32 v18, v47, v16
    v_fmac_f32 v17, v18, v18
    v_sub_f32 v18, v48, v16
    v_fmac_f32 v17, v18, v18
    v_sub_f32 v18, v49, v16
    v_fmac_f32 v17, v18, v18
    v_sub_f32 v18, v50, v16
    v_fmac_f32 v17, v18, v18
    v_sub_f32 v18, v51, v16
    v_fmac_f32 v17, v18, v18
    v_sub_f32 v18, v52, v16
    v_fmac_f32 v17, v18, v18
    v_sub_f32 v18, v53, v16
    v_fmac_f32 v17, v18, v18
    v_sub_f32 v18, v54, v16
    v_fmac_f32 v17, v18, v18
    v_sub_f32 v18, v55, v16
    v_fmac_f32 v17, v18, v18
    v_sub_f32 v18, v56, v16
    v_fmac_f32 v17, v18, v18
    v_sub_f32 v18, v57, v16
    v_fmac_f32 v17, v18, v18
    v_sub_f32 v18, v58, v16
    v_fmac_f32 v17, v18, v18
    v_sub_f32 v18, v59, v16
    v_fmac_f32 v17, v18, v18
    v_sub_f32 v18, v60, v16
    v_fmac_f32 v17, v18, v18
    v_sub_f32 v18, v61, v16
    v_fmac_f32 v17, v18, v18
    s_nop 1
    v_add_f32_dpp v17, v17, v17 row_ror:8 row_mask:0xf bank_mask:0xf
    s_nop 1
    v_add_f32_dpp v17, v17, v17 row_ror:4 row_mask:0xf bank_mask:0xf
    s_nop 1
    v_add_f32_dpp v17, v17, v17 row_ror:2 row_mask:0xf bank_mask:0xf
    s_nop 1
    v_add_f32_dpp v17, v17, v17 row_ror:1 row_mask:0xf bank_mask:0xf
    v_mov_b32 v18, v17
    s_nop 1
    v_permlane16_swap_b32 v17, v18
    v_add_f32 v17, v17, v18
    v_mul_f32 v17, 0x3ae38e39, v17
    v_cvt_pk_bf16_f32 v16, v16, v16
    v_and_b32 v16, 0xffff0000, v16
    v_cvt_pk_bf16_f32 v17, v17, v17
    v_and_b32 v17, 0xffff0000, v17
    v_add_f32 v17, 0x3727c5ac, v17
    v_cvt_pk_bf16_f32 v17, v17, v17
    v_and_b32 v17, 0xffff0000, v17
    v_sqrt_f32 v17, v17
    s_nop 0
    v_cvt_pk_bf16_f32 v17, v17, v17
    v_and_b32 v17, 0xffff0000, v17
    v_rcp_f32 v17, v17
    s_waitcnt vmcnt(0)
    v_lshlrev_b32 v20, 16, v104
    v_and_b32 v21, 0xffff0000, v104
    v_lshlrev_b32 v22, 16, v105
    v_and_b32 v23, 0xffff0000, v105
    v_sub_f32 v20, v20, v16
    v_cvt_pk_bf16_f32 v20, v20, v20
    v_and_b32 v20, 0xffff0000, v20
    v_mul_f32 v20, v20, v17
    v_cvt_pk_bf16_f32 v20, v20, v20
    v_and_b32 v20, 0xffff0000, v20
    v_sub_f32 v21, v21, v16
    v_cvt_pk_bf16_f32 v21, v21, v21
    v_and_b32 v21, 0xffff0000, v21
    v_mul_f32 v21, v21, v17
    v_cvt_pk_bf16_f32 v21, v21, v21
    v_and_b32 v21, 0xffff0000, v21
    v_sub_f32 v22, v22, v16
    v_cvt_pk_bf16_f32 v22, v22, v22
    v_and_b32 v22, 0xffff0000, v22
    v_mul_f32 v22, v22, v17
    v_cvt_pk_bf16_f32 v22, v22, v22
    v_and_b32 v22, 0xffff0000, v22
    v_sub_f32 v23, v23, v16
    v_cvt_pk_bf16_f32 v23, v23, v23
    v_and_b32 v23, 0xffff0000, v23
    v_mul_f32 v23, v23, v17
    v_cvt_pk_bf16_f32 v23, v23, v23
    v_and_b32 v23, 0xffff0000, v23
    s_waitcnt lgkmcnt(0)
    s_add_u32 s97, s97, 1
    s_and_b32 s99, s97, s96
    v_mov_b32 v0, s99
Lsp_47:
    ds_read_b32 v4, v5 offset:7496
    s_waitcnt lgkmcnt(0)
    v_readfirstlane_b32 s11, v4
    s_cmp_lg_u32 s11, 0
    s_cbranch_scc1 Lspd_48
    s_sleep 1
    s_sub_u32 s70, s70, 1
    s_cmp_gt_i32 s70, 0
    s_cbranch_scc1 Lsp_47
Lspd_48:
Lpo_49:
    s_mov_b32 s15, 2097152
    buffer_load_dwordx4 v[32:35], v10, s[44:47], s15 offen sc1
    buffer_load_dwordx4 v[36:39], v10, s[44:47], s15 offen offset:2304 sc1
    s_mov_b32 s15, 2124800
    buffer_load_dwordx4 v[40:43], v10, s[44:47], s15 offen sc1
    buffer_load_dwordx4 v[44:47], v10, s[44:47], s15 offen offset:2304 sc1
    s_mov_b32 s15, 2152448
    buffer_load_dwordx4 v[48:51], v10, s[44:47], s15 offen sc1
    buffer_load_dwordx4 v[52:55], v10, s[44:47], s15 offen offset:2304 sc1
    s_mov_b32 s15, 2180096
    buffer_load_dwordx4 v[56:59], v10, s[44:47], s15 offen sc1
    buffer_load_dwordx4 v[60:63], v10, s[44:47], s15 offen offset:2304 sc1
    s_mov_b32 s15, 2207744
    buffer_load_dwordx4 v[64:67], v10, s[44:47], s15 offen sc1
    buffer_load_dwordx4 v[68:71], v10, s[44:47], s15 offen offset:2304 sc1
    s_mov_b32 s15, 2235392
    buffer_load_dwordx4 v[72:75], v10, s[44:47], s15 offen sc1
    buffer_load_dwordx4 v[76:79], v10, s[44:47], s15 offen offset:2304 sc1
    s_mov_b32 s15, 2263040
    buffer_load_dwordx4 v[80:83], v10, s[44:47], s15 offen sc1
    buffer_load_dwordx4 v[84:87], v10, s[44:47], s15 offen offset:2304 sc1
    s_mov_b32 s15, 2290688
    buffer_load_dwordx4 v[88:91], v10, s[44:47], s15 offen sc1
    buffer_load_dwordx4 v[92:95], v10, s[44:47], s15 offen offset:2304 sc1
    s_mov_b32 s15, 2318336
    buffer_load_dwordx4 v[96:99], v10, s[44:47], s15 offen sc1
    buffer_load_dwordx4 v[100:103], v10, s[44:47], s15 offen offset:2304 sc1
    s_waitcnt vmcnt(0)
Lpoc_51:
    v_xor_b32 v9, v32, v0
    v_bitop3_b32 v9, v9, v33, v0 bitop3:0xf6
    v_bitop3_b32 v9, v9, v34, v0 bitop3:0xf6
    v_bitop3_b32 v9, v9, v35, v0 bitop3:0xf6
    v_bitop3_b32 v9, v9, v36, v0 bitop3:0xf6
    v_bitop3_b32 v9, v9, v37, v0 bitop3:0xf6
    v_bitop3_b32 v9, v9, v38, v0 bitop3:0xf6
    v_bitop3_b32 v9, v9, v39, v0 bitop3:0xf6
    v_bitop3_b32 v9, v9, v40, v0 bitop3:0xf6
    v_bitop3_b32 v9, v9, v41, v0 bitop3:0xf6
    v_bitop3_b32 v9, v9, v42, v0 bitop3:0xf6
    v_bitop3_b32 v9, v9, v43, v0 bitop3:0xf6
    v_bitop3_b32 v9, v9, v44, v0 bitop3:0xf6
    v_bitop3_b32 v9, v9, v45, v0 bitop3:0xf6
    v_bitop3_b32 v9, v9, v46, v0 bitop3:0xf6
    v_bitop3_b32 v9, v9, v47, v0 bitop3:0xf6
    v_bitop3_b32 v9, v9, v48, v0 bitop3:0xf6
    v_bitop3_b32 v9, v9, v49, v0 bitop3:0xf6
    v_bitop3_b32 v9, v9, v50, v0 bitop3:0xf6
    v_bitop3_b32 v9, v9, v51, v0 bitop3:0xf6
    v_bitop3_b32 v9, v9, v52, v0 bitop3:0xf6
    v_bitop3_b32 v9, v9, v53, v0 bitop3:0xf6
    v_bitop3_b32 v9, v9, v54, v0 bitop3:0xf6
    v_bitop3_b32 v9, v9, v55, v0 bitop3:0xf6
    v_bitop3_b32 v9, v9, v56, v0 bitop3:0xf6
    v_bitop3_b32 v9, v9, v57, v0 bitop3:0xf6
    v_bitop3_b32 v9, v9, v58, v0 bitop3:0xf6
    v_bitop3_b32 v9, v9, v59, v0 bitop3:0xf6
    v_bitop3_b32 v9, v9, v60, v0 bitop3:0xf6
    v_bitop3_b32 v9, v9, v61, v0 bitop3:0xf6
    v_bitop3_b32 v9, v9, v62, v0 bitop3:0xf6
    v_bitop3_b32 v9, v9, v63, v0 bitop3:0xf6
    v_bitop3_b32 v9, v9, v64, v0 bitop3:0xf6
    v_bitop3_b32 v9, v9, v65, v0 bitop3:0xf6
    v_bitop3_b32 v9, v9, v66, v0 bitop3:0xf6
    v_bitop3_b32 v9, v9, v67, v0 bitop3:0xf6
    v_bitop3_b32 v9, v9, v68, v0 bitop3:0xf6
    v_bitop3_b32 v9, v9, v69, v0 bitop3:0xf6
    v_bitop3_b32 v9, v9, v70, v0 bitop3:0xf6
    v_bitop3_b32 v9, v9, v71, v0 bitop3:0xf6
    v_bitop3_b32 v9, v9, v72, v0 bitop3:0xf6
    v_bitop3_b32 v9, v9, v73, v0 bitop3:0xf6
    v_bitop3_b32 v9, v9, v74, v0 bitop3:0xf6
    v_bitop3_b32 v9, v9, v75, v0 bitop3:0xf6
    v_bitop3_b32 v9, v9, v76, v0 bitop3:0xf6
    v_bitop3_b32 v9, v9, v77, v0 bitop3:0xf6
    v_bitop3_b32 v9, v9, v78, v0 bitop3:0xf6
    v_bitop3_b32 v9, v9, v79, v0 bitop3:0xf6
    v_bitop3_b32 v9, v9, v80, v0 bitop3:0xf6
    v_bitop3_b32 v9, v9, v81, v0 bitop3:0xf6
    v_bitop3_b32 v9, v9, v82, v0 bitop3:0xf6
    v_bitop3_b32 v9, v9, v83, v0 bitop3:0xf6
    v_bitop3_b32 v9, v9, v84, v0 bitop3:0xf6
    v_bitop3_b32 v9, v9, v85, v0 bitop3:0xf6
    v_bitop3_b32 v9, v9, v86, v0 bitop3:0xf6
    v_bitop3_b32 v9, v9, v87, v0 bitop3:0xf6
    v_bitop3_b32 v9, v9, v88, v0 bitop3:0xf6
    v_bitop3_b32 v9, v9, v89, v0 bitop3:0xf6
    v_bitop3_b32 v9, v9, v90, v0 bitop3:0xf6
    v_bitop3_b32 v9, v9, v91, v0 bitop3:0xf6
    v_bitop3_b32 v9, v9, v92, v0 bitop3:0xf6
    v_bitop3_b32 v9, v9, v93, v0 bitop3:0xf6
    v_bitop3_b32 v9, v9, v94, v0 bitop3:0xf6
    v_bitop3_b32 v9, v9, v95, v0 bitop3:0xf6
    v_bitop3_b32 v9, v9, v96, v0 bitop3:0xf6
    v_bitop3_b32 v9, v9, v97, v0 bitop3:0xf6
    v_bitop3_b32 v9, v9, v98, v0 bitop3:0xf6
    v_bitop3_b32 v9, v9, v99, v0 bitop3:0xf6
    v_bitop3_b32 v9, v9, v100, v0 bitop3:0xf6
    v_bitop3_b32 v9, v9, v101, v0 bitop3:0xf6
    v_bitop3_b32 v9, v9, v102, v0 bitop3:0xf6
    v_bitop3_b32 v9, v9, v103, v0 bitop3:0xf6
    v_and_b32 v9, s96, v9
    v_cmp_ne_u32 vcc, 0, v9
    s_nop 0
    s_and_b64 vcc, vcc, s[12:13]
    s_cbranch_scc0 Lpod_50
    s_sleep 2
    s_sub_u32 s70, s70, 1
    s_cmp_gt_i32 s70, 0
    s_cbranch_scc1 Lpo_49
Lpod_50:
    v_and_b32 v32, s98, v32
    v_and_b32 v33, s98, v33
    v_and_b32 v34, s98, v34
    v_and_b32 v35, s98, v35
    v_and_b32 v36, s98, v36
    v_and_b32 v37, s98, v37
    v_and_b32 v38, s98, v38
    v_and_b32 v39, s98, v39
    v_and_b32 v40, s98, v40
    v_and_b32 v41, s98, v41
    v_and_b32 v42, s98, v42
    v_and_b32 v43, s98, v43
    v_and_b32 v44, s98, v44
    v_and_b32 v45, s98, v45
    v_and_b32 v46, s98, v46
    v_and_b32 v47, s98, v47
    v_and_b32 v48, s98, v48
    v_and_b32 v49, s98, v49
    v_and_b32 v50, s98, v50
    v_and_b32 v51, s98, v51
    v_and_b32 v52, s98, v52
    v_and_b32 v53, s98, v53
    v_and_b32 v54, s98, v54
    v_and_b32 v55, s98, v55
    v_and_b32 v56, s98, v56
    v_and_b32 v57, s98, v57
    v_and_b32 v58, s98, v58
    v_and_b32 v59, s98, v59
    v_and_b32 v60, s98, v60
    v_and_b32 v61, s98, v61
    v_and_b32 v62, s98, v62
    v_and_b32 v63, s98, v63
    v_and_b32 v64, s98, v64
    v_and_b32 v65, s98, v65
    v_and_b32 v66, s98, v66
    v_and_b32 v67, s98, v67
    v_and_b32 v68, s98, v68
    v_and_b32 v69, s98, v69
    v_and_b32 v70, s98, v70
    v_and_b32 v71, s98, v71
    v_and_b32 v72, s98, v72
    v_and_b32 v73, s98, v73
    v_and_b32 v74, s98, v74
    v_and_b32 v75, s98, v75
    v_and_b32 v76, s98, v76
    v_and_b32 v77, s98, v77
    v_and_b32 v78, s98, v78
    v_and_b32 v79, s98, v79
    v_and_b32 v80, s98, v80
    v_and_b32 v81, s98, v81
    v_and_b32 v82, s98, v82
    v_and_b32 v83, s98, v83
    v_and_b32 v84, s98, v84
    v_and_b32 v85, s98, v85
    v_and_b32 v86, s98, v86
    v_and_b32 v87, s98, v87
    v_and_b32 v88, s98, v88
    v_and_b32 v89, s98, v89
    v_and_b32 v90, s98, v90
    v_and_b32 v91, s98, v91
    v_and_b32 v92, s98, v92
    v_and_b32 v93, s98, v93
    v_and_b32 v94, s98, v94
    v_and_b32 v95, s98, v95
    v_and_b32 v96, s98, v96
    v_and_b32 v97, s98, v97
    v_and_b32 v98, s98, v98
    v_and_b32 v99, s98, v99
    v_and_b32 v100, s98, v100
    v_and_b32 v101, s98, v101
    v_and_b32 v102, s98, v102
    v_and_b32 v103, s98, v103
    v_pk_add_f32 v[32:33], v[32:33], v[40:41]
    v_pk_add_f32 v[34:35], v[34:35], v[42:43]
    v_pk_add_f32 v[36:37], v[36:37], v[44:45]
    v_pk_add_f32 v[38:39], v[38:39], v[46:47]
    v_pk_add_f32 v[32:33], v[32:33], v[48:49]
    v_pk_add_f32 v[34:35], v[34:35], v[50:51]
    v_pk_add_f32 v[36:37], v[36:37], v[52:53]
    v_pk_add_f32 v[38:39], v[38:39], v[54:55]
    v_pk_add_f32 v[32:33], v[32:33], v[56:57]
    v_pk_add_f32 v[34:35], v[34:35], v[58:59]
    v_pk_add_f32 v[36:37], v[36:37], v[60:61]
    v_pk_add_f32 v[38:39], v[38:39], v[62:63]
    v_pk_add_f32 v[32:33], v[32:33], v[64:65]
    v_pk_add_f32 v[34:35], v[34:35], v[66:67]
    v_pk_add_f32 v[36:37], v[36:37], v[68:69]
    v_pk_add_f32 v[38:39], v[38:39], v[70:71]
    v_pk_add_f32 v[32:33], v[32:33], v[72:73]
    v_pk_add_f32 v[34:35], v[34:35], v[74:75]
    v_pk_add_f32 v[36:37], v[36:37], v[76:77]
    v_pk_add_f32 v[38:39], v[38:39], v[78:79]
    v_pk_add_f32 v[32:33], v[32:33], v[80:81]
    v_pk_add_f32 v[34:35], v[34:35], v[82:83]
    v_pk_add_f32 v[36:37], v[36:37], v[84:85]
    v_pk_add_f32 v[38:39], v[38:39], v[86:87]
    v_pk_add_f32 v[32:33], v[32:33], v[88:89]
    v_pk_add_f32 v[34:35], v[34:35], v[90:91]
    v_pk_add_f32 v[36:37], v[36:37], v[92:93]
    v_pk_add_f32 v[38:39], v[38:39], v[94:95]
    v_pk_add_f32 v[32:33], v[32:33], v[96:97]
    v_pk_add_f32 v[34:35], v[34:35], v[98:99]
    v_pk_add_f32 v[36:37], v[36:37], v[100:101]
    v_pk_add_f32 v[38:39], v[38:39], v[102:103]
    v_cvt_pk_bf16_f32 v32, v32, v32
    v_and_b32 v32, 0xffff0000, v32
    v_cvt_pk_bf16_f32 v36, v36, v36
    v_and_b32 v36, 0xffff0000, v36
    v_add_f32 v36, 1.0, v36
    v_cvt_pk_bf16_f32 v36, v36, v36
    v_and_b32 v36, 0xffff0000, v36
    v_mul_f32 v20, v20, v36
    v_cvt_pk_bf16_f32 v20, v20, v20
    v_and_b32 v20, 0xffff0000, v20
    v_add_f32 v20, v20, v32
    v_cvt_pk_bf16_f32 v20, v20, v20
    ds_write_b32 v111, v20 offset:0
    v_cvt_pk_bf16_f32 v33, v33, v33
    v_and_b32 v33, 0xffff0000, v33
    v_cvt_pk_bf16_f32 v37, v37, v37
    v_and_b32 v37, 0xffff0000, v37
    v_add_f32 v37, 1.0, v37
    v_cvt_pk_bf16_f32 v37, v37, v37
    v_and_b32 v37, 0xffff0000, v37
    v_mul_f32 v21, v21, v37
    v_cvt_pk_bf16_f32 v21, v21, v21
    v_and_b32 v21, 0xffff0000, v21
    v_add_f32 v21, v21, v33
    v_cvt_pk_bf16_f32 v21, v21, v21
    ds_write_b32 v111, v21 offset:80
    v_cvt_pk_bf16_f32 v34, v34, v34
    v_and_b32 v34, 0xffff0000, v34
    v_cvt_pk_bf16_f32 v38, v38, v38
    v_and_b32 v38, 0xffff0000, v38
    v_add_f32 v38, 1.0, v38
    v_cvt_pk_bf16_f32 v38, v38, v38
    v_and_b32 v38, 0xffff0000, v38
    v_mul_f32 v22, v22, v38
    v_cvt_pk_bf16_f32 v22, v22, v22
    v_and_b32 v22, 0xffff0000, v22
    v_add_f32 v22, v22, v34
    v_cvt_pk_bf16_f32 v22, v22, v22
    ds_write_b32 v111, v22 offset:160
    v_cvt_pk_bf16_f32 v35, v35, v35
    v_and_b32 v35, 0xffff0000, v35
    v_cvt_pk_bf16_f32 v39, v39, v39
    v_and_b32 v39, 0xffff0000, v39
    v_add_f32 v39, 1.0, v39
    v_cvt_pk_bf16_f32 v39, v39, v39
    v_and_b32 v39, 0xffff0000, v39
    v_mul_f32 v23, v23, v39
    v_cvt_pk_bf16_f32 v23, v23, v23
    v_and_b32 v23, 0xffff0000, v23
    v_add_f32 v23, v23, v35
    v_cvt_pk_bf16_f32 v23, v23, v23
    ds_write_b32 v111, v23 offset:240
    s_waitcnt lgkmcnt(0)
    v_mov_b32 v4, 1
    ds_write_b32 v5, v4 offset:7492
Lbulk:
Lsp_52:
    ds_read_b32 v4, v5 offset:7488
    s_waitcnt lgkmcnt(0)
    v_readfirstlane_b32 s11, v4
    s_cmp_lg_u32 s11, 0
    s_cbranch_scc1 Lspd_53
    s_sleep 1
    s_sub_u32 s70, s70, 1
    s_cmp_gt_i32 s70, 0
    s_cbranch_scc1 Lsp_52
Lspd_53:
    s_cmp_eq_u32 s69, 1
    s_cbranch_scc1 Lpf1
    s_mov_b32 s52, s28
    s_and_b32 s53, s29, 0xffff
    s_mov_b32 s54, 5308416
    s_mov_b32 s55, 0x20000
    s_mov_b32 s56, s30
    s_and_b32 s57, s31, 0xffff
    s_mov_b32 s58, 5308416
    s_mov_b32 s59, 0x20000
    s_sub_u32 s11, s8, 18
    s_lshl_b32 s11, s11, 3
    s_add_u32 s11, s11, s4
    s_lshl_b32 s11, s11, 3
    v_lshrrev_b32 v6, 3, v1
    v_add_u32 v6, s11, v6
    s_mul_i32 s12, s9, 1152
    v_and_b32 v7, 7, v1
    v_lshl_add_u32 v7, v7, 4, s12
    v_mul_u32_u24 v8, 7282, v6
    v_lshrrev_b32 v8, 16, v8
    v_mul_u32_u24 v9, 9, v8
    v_sub_u32 v9, v6, v9
    v_mul_u32_u24 v8, 9216, v8
    v_lshl_add_u32 v8, v9, 7, v8
    v_add_u32 v8, v8, v7
    buffer_load_dwordx4 v[32:35], v8, s[52:55], 0 offen
    s_waitcnt vmcnt(1)
    buffer_load_dwordx4 v[36:39], v8, s[56:59], 0 offen
    s_waitcnt vmcnt(1)
    v_add_u32 v6, 896, v6
    v_mul_u32_u24 v8, 7282, v6
    v_lshrrev_b32 v8, 16, v8
    v_mul_u32_u24 v9, 9, v8
    v_sub_u32 v9, v6, v9
    v_mul_u32_u24 v8, 9216, v8
    v_lshl_add_u32 v8, v9, 7, v8
    v_add_u32 v8, v8, v7
    buffer_load_dwordx4 v[32:35], v8, s[52:55], 0 offen
    s_waitcnt vmcnt(1)
    buffer_load_dwordx4 v[36:39], v8, s[56:59], 0 offen
    s_waitcnt vmcnt(1)
    v_add_u32 v6, 896, v6
    v_mul_u32_u24 v8, 7282, v6
    v_lshrrev_b32 v8, 16, v8
    v_mul_u32_u24 v9, 9, v8
    v_sub_u32 v9, v6, v9
    v_mul_u32_u24 v8, 9216, v8
    v_lshl_add_u32 v8, v9, 7, v8
    v_add_u32 v8, v8, v7
    buffer_load_dwordx4 v[32:35], v8, s[52:55], 0 offen
    s_waitcnt vmcnt(1)
    buffer_load_dwordx4 v[36:39], v8, s[56:59], 0 offen
    s_waitcnt vmcnt(1)
    v_add_u32 v6, 896, v6
    v_mul_u32_u24 v8, 7282, v6
    v_lshrrev_b32 v8, 16, v8
    v_mul_u32_u24 v9, 9, v8
    v_sub_u32 v9, v6, v9
    v_mul_u32_u24 v8, 9216, v8
    v_lshl_add_u32 v8, v9, 7, v8
    v_add_u32 v8, v8, v7
    buffer_load_dwordx4 v[32:35], v8, s[52:55], 0 offen
    s_waitcnt vmcnt(1)
    buffer_load_dwordx4 v[36:39], v8, s[56:59], 0 offen
    s_waitcnt vmcnt(1)
    v_add_u32 v6, 896, v6
    v_mul_u32_u24 v8, 7282, v6
    v_lshrrev_b32 v8, 16, v8
    v_mul_u32_u24 v9, 9, v8
    v_sub_u32 v9, v6, v9
    v_mul_u32_u24 v8, 9216, v8
    v_lshl_add_u32 v8, v9, 7, v8
    v_add_u32 v8, v8, v7
    buffer_load_dwordx4 v[32:35], v8, s[52:55], 0 offen
    s_waitcnt vmcnt(1)
    buffer_load_dwordx4 v[36:39], v8, s[56:59], 0 offen
    s_waitcnt vmcnt(1)
    v_add_u32 v6, 896, v6
    v_mul_u32_u24 v8, 7282, v6
    v_lshrrev_b32 v8, 16, v8
    v_mul_u32_u24 v9, 9, v8
    v_sub_u32 v9, v6, v9
    v_mul_u32_u24 v8, 9216, v8
    v_lshl_add_u32 v8, v9, 7, v8
    v_add_u32 v8, v8, v7
    buffer_load_dwordx4 v[32:35], v8, s[52:55], 0 offen
    s_waitcnt vmcnt(1)
    buffer_load_dwordx4 v[36:39], v8, s[56:59], 0 offen
    s_waitcnt vmcnt(1)
    v_add_u32 v6, 896, v6
Lpf1:
    s_mov_b32 s48, s24
    s_and_b32 s49, s25, 0xffff
    s_mov_b32 s50, 4718592
    s_mov_b32 s51, 0x20000
    s_lshl_b32 s11, s5, 7
    s_and_b32 s12, s7, 1
    s_lshl_b32 s12, s12, 6
    s_add_u32 s11, s11, s12
    v_lshrrev_b32 v6, 3, v2
    v_lshl_add_u32 v6, v3, 4, v6
    v_add_u32 v6, s11, v6
    v_mul_u32_u24 v6, 1152, v6
    v_and_b32 v7, 7, v1
    v_lshl_add_u32 v6, v7, 4, v6
    s_lshl_b32 s15, s4, 7
    buffer_load_dwordx4 v[32:35], v6, s[48:51], s15 offen
    s_add_u32 s15, s15, 2304
    s_waitcnt vmcnt(1)
    buffer_load_dwordx4 v[36:39], v6, s[48:51], s15 offen
    s_add_u32 s15, s15, 2304
    s_waitcnt vmcnt(1)
    buffer_load_dwordx4 v[40:43], v6, s[48:51], s15 offen
    s_add_u32 s15, s15, 2304
    s_waitcnt vmcnt(1)
    buffer_load_dwordx4 v[44:47], v6, s[48:51], s15 offen
    s_add_u32 s15, s15, 2304
    s_waitcnt vmcnt(1)
    buffer_load_dwordx4 v[48:51], v6, s[48:51], s15 offen
    s_add_u32 s15, s15, 2304
    s_waitcnt vmcnt(1)
    buffer_load_dwordx4 v[52:55], v6, s[48:51], s15 offen
    s_add_u32 s15, s15, 2304
    s_waitcnt vmcnt(1)
    buffer_load_dwordx4 v[56:59], v6, s[48:51], s15 offen
    s_add_u32 s15, s15, 2304
    s_waitcnt vmcnt(1)
    buffer_load_dwordx4 v[60:63], v6, s[48:51], s15 offen
    s_add_u32 s15, s15, 2304
    s_waitcnt vmcnt(1)
    s_cmp_lg_u32 s4, 0
    s_cbranch_scc1 Lb1
    s_movk_i32 s15, 1024
    buffer_load_dwordx4 v[64:67], v6, s[48:51], s15 offen
    s_add_u32 s15, s15, 2304
    s_waitcnt vmcnt(1)
    buffer_load_dwordx4 v[68:71], v6, s[48:51], s15 offen
    s_add_u32 s15, s15, 2304
    s_waitcnt vmcnt(1)
    buffer_load_dwordx4 v[72:75], v6, s[48:51], s15 offen
    s_add_u32 s15, s15, 2304
    s_waitcnt vmcnt(1)
    buffer_load_dwordx4 v[76:79], v6, s[48:51], s15 offen
    s_add_u32 s15, s15, 2304
    s_waitcnt vmcnt(1)
    buffer_load_dwordx4 v[80:83], v6, s[48:51], s15 offen
    s_add_u32 s15, s15, 2304
    s_waitcnt vmcnt(1)
    buffer_load_dwordx4 v[84:87], v6, s[48:51], s15 offen
    s_add_u32 s15, s15, 2304
    s_waitcnt vmcnt(1)
    buffer_load_dwordx4 v[88:91], v6, s[48:51], s15 offen
    s_add_u32 s15, s15, 2304
    s_waitcnt vmcnt(1)
    buffer_load_dwordx4 v[92:95], v6, s[48:51], s15 offen
    s_add_u32 s15, s15, 2304
    s_waitcnt vmcnt(1)
Lb1:
    s_cmp_lg_u32 s69, 1
    s_cbranch_scc1 Lb3
    s_cmp_lt_u32 s4, 3
    s_cbranch_scc1 Lb2
    s_mov_b32 s56, s32
    s_and_b32 s57, s33, 0xffff
    s_mov_b32 s58, 5308416
    s_mov_b32 s59, 0x20000
    s_lshl_b32 s11, s10, 5
    v_add_u32 v6, s11, v3
    v_mul_u32_u24 v6, 1152, v6
    s_sub_u32 s12, s4, 3
    s_lshl_b32 s12, s12, 8
    v_lshl_add_u32 v7, v2, 4, s12
    v_cmp_gt_u32 vcc, 1152, v7
    v_add_u32 v6, v6, v7
    v_mov_b32 v8, 1073741824
    v_cndmask_b32 v6, v8, v6, vcc
    s_mov_b32 s15, 0
    buffer_load_dwordx4 v[72:75], v6, s[56:59], s15 offen nt
    s_add_u32 s15, s15, 4608
    s_waitcnt vmcnt(1)
    buffer_load_dwordx4 v[76:79], v6, s[56:59], s15 offen nt
    s_add_u32 s15, s15, 4608
    s_waitcnt vmcnt(1)
    buffer_load_dwordx4 v[80:83], v6, s[56:59], s15 offen nt
    s_add_u32 s15, s15, 4608
    s_waitcnt vmcnt(1)
    buffer_load_dwordx4 v[84:87], v6, s[56:59], s15 offen nt
    s_add_u32 s15, s15, 4608
    s_waitcnt vmcnt(1)
    buffer_load_dwordx4 v[88:91], v6, s[56:59], s15 offen nt
    s_add_u32 s15, s15, 4608
    s_waitcnt vmcnt(1)
    buffer_load_dwordx4 v[92:95], v6, s[56:59], s15 offen nt
    s_add_u32 s15, s15, 4608
    s_waitcnt vmcnt(1)
    buffer_load_dwordx4 v[96:99], v6, s[56:59], s15 offen nt
    s_add_u32 s15, s15, 4608
    s_waitcnt vmcnt(1)
    buffer_load_dwordx4 v[100:103], v6, s[56:59], s15 offen nt
    s_add_u32 s15, s15, 4608
    s_waitcnt vmcnt(1)
    v_lshrrev_b32 v6, 1, v3
    v_mul_u32_u24 v6, 36, v6
    v_lshrrev_b32 v7, 5, v7
    v_add_u32 v6, v6, v7
    v_mul_u32_u24 v6, 9216, v6
    v_and_b32 v7, 1, v2
    v_lshl_add_u32 v6, v7, 5, v6
    v_and_b32 v7, 1, v3
    v_lshl_add_u32 v6, v7, 4, v6
    s_lshl_b32 s11, s10, 6
    s_add_u32 s11, s11, 1376256
    v_add_u32 v6, s11, v6
    v_cndmask_b32 v110, v8, v6, vcc
Lb2:
    v_cmp_gt_u32 vcc, 36, v1
    s_mul_i32 s11, s4, 576
    v_lshl_add_u32 v6, v1, 4, s11
    v_mov_b32 v8, 1073741824
    v_cndmask_b32 v111, v8, v6, vcc
    s_mov_b32 s12, 2056192
    s_mov_b32 s13, 2060800
    s_mov_b64 s[14:15], vcc
Lsp_54:
    ds_read_b32 v4, v5 offset:7488
    s_waitcnt lgkmcnt(0)
    v_readfirstlane_b32 s11, v4
    s_cmp_lg_u32 s11, 0
    s_cbranch_scc1 Lspd_55
    s_sleep 1
    s_sub_u32 s70, s70, 1
    s_cmp_gt_i32 s70, 0
    s_cbranch_scc1 Lsp_54
Lspd_55:
Lpo_56:
    buffer_load_dwordx4 v[24:27], v111, s[44:47], s12 offen sc1
    buffer_load_dwordx4 v[28:31], v111, s[44:47], s13 offen sc1
    s_waitcnt vmcnt(0)
Lpoc_58:
    v_xor_b32 v8, v24, v0
    v_bitop3_b32 v8, v8, v25, v0 bitop3:0xf6
    v_bitop3_b32 v8, v8, v26, v0 bitop3:0xf6
    v_bitop3_b32 v8, v8, v27, v0 bitop3:0xf6
    v_bitop3_b32 v8, v8, v28, v0 bitop3:0xf6
    v_bitop3_b32 v8, v8, v29, v0 bitop3:0xf6
    v_bitop3_b32 v8, v8, v30, v0 bitop3:0xf6
    v_bitop3_b32 v8, v8, v31, v0 bitop3:0xf6
    v_and_b32 v8, s96, v8
    v_cmp_ne_u32 vcc, 0, v8
    s_nop 0
    s_and_b64 vcc, vcc, s[14:15]
    s_cbranch_scc0 Lpod_57
    s_sleep 8
    s_sub_u32 s70, s70, 1
    s_cmp_gt_i32 s70, 0
    s_cbranch_scc1 Lpo_56
Lpod_57:
    v_and_b32 v24, s98, v24
    v_and_b32 v25, s98, v25
    v_and_b32 v26, s98, v26
    v_and_b32 v27, s98, v27
    v_and_b32 v28, s98, v28
    v_and_b32 v29, s98, v29
    v_and_b32 v30, s98, v30
    v_and_b32 v31, s98, v31
Lb3:
    s_cmp_lg_u32 s4, 1
    s_cbranch_scc1 Lb4
Lsp_59:
    ds_read_b32 v4, v5 offset:7488
    s_waitcnt lgkmcnt(0)
    v_readfirstlane_b32 s11, v4
    s_cmp_lg_u32 s11, 0
    s_cbranch_scc1 Lspd_60
    s_sleep 1
    s_sub_u32 s70, s70, 1
    s_cmp_gt_i32 s70, 0
    s_cbranch_scc1 Lsp_59
Lspd_60:
    v_cmp_gt_u32 vcc, 32, v1
    v_lshlrev_b32 v6, 3, v1
    v_mov_b32 v8, 1073741824
    v_cndmask_b32 v6, v8, v6, vcc
    s_and_b32 s11, s3, 0xfc
    s_lshl_b32 s11, s11, 6
    s_add_u32 s12, s11, 2039808
    s_mov_b64 s[14:15], vcc
Lpo_61:
    buffer_load_dwordx2 v[16:17], v6, s[44:47], s12 offen sc1
    s_waitcnt vmcnt(0)
Lpoc_63:
    v_xor_b32 v8, v16, v0
    v_bitop3_b32 v8, v8, v17, v0 bitop3:0xf6
    v_and_b32 v8, s96, v8
    v_cmp_ne_u32 vcc, 0, v8
    s_nop 0
    s_and_b64 vcc, vcc, s[14:15]
    s_cbranch_scc0 Lpod_62
    s_sleep 16
    s_sub_u32 s70, s70, 1
    s_cmp_gt_i32 s70, 0
    s_cbranch_scc1 Lpo_61
Lpod_62:
    v_and_b32 v16, s98, v16
    v_and_b32 v17, s98, v17
    v_mov_b32 v18, v16
    s_nop 1
    v_max_f32_dpp v18, v18, v18 row_ror:8 row_mask:0xf bank_mask:0xf
    s_nop 1
    v_max_f32_dpp v18, v18, v18 row_ror:4 row_mask:0xf bank_mask:0xf
    s_nop 1
    v_max_f32_dpp v18, v18, v18 row_ror:2 row_mask:0xf bank_mask:0xf
    s_nop 1
    v_max_f32_dpp v18, v18, v18 row_ror:1 row_mask:0xf bank_mask:0xf
    v_mov_b32 v19, v18
    s_nop 1
    v_permlane16_swap_b32 v18, v19
    v_max_f32 v18, v18, v19
    v_sub_f32 v16, v16, v18
    v_mul_f32 v16, 0x3fb8aa3b, v16
    v_exp_f32 v16, v16
    s_nop 0
    v_mul_f32 v17, v16, v17
    s_nop 1
    v_add_f32_dpp v17, v17, v17 row_ror:8 row_mask:0xf bank_mask:0xf
    s_nop 1
    v_add_f32_dpp v17, v17, v17 row_ror:4 row_mask:0xf bank_mask:0xf
    s_nop 1
    v_add_f32_dpp v17, v17, v17 row_ror:2 row_mask:0xf bank_mask:0xf
    s_nop 1
    v_add_f32_dpp v17, v17, v17 row_ror:1 row_mask:0xf bank_mask:0xf
    v_mov_b32 v19, v17
    s_nop 1
    v_permlane16_swap_b32 v17, v19
    v_add_f32 v17, v17, v19
    v_rcp_f32 v17, v17
    v_lshlrev_b32 v6, 2, v1
    v_add_u32 v7, 7296, v6
    v_add_u32 v6, 10880, v6
    v_cmp_gt_u32 vcc, 32, v1
    s_nop 1
    v_cndmask_b32 v6, v6, v7, vcc
    v_mul_f32 v16, v16, v17
    ds_write_b32 v6, v16
    s_waitcnt lgkmcnt(0)
    v_mov_b32 v4, 1
    ds_write_b32 v5, v4 offset:7500
Lb4:
    v_lshrrev_b32 v6, 1, v2
    v_lshlrev_b32 v6, 13, v6
    v_and_b32 v7, 1, v2
    v_lshl_add_u32 v6, v7, 5, v6
    v_lshl_add_u32 v6, v3, 4, v6
    v_and_b32 v7, 40, v1
    v_cmp_eq_u32 vcc, 0, v7
    v_mov_b32 v8, 1073741824
    s_nop 0
    v_cndmask_b32 v106, v8, v6, vcc
    s_mul_i32 s11, s6, 36
    s_lshl_b32 s11, s11, 13
    s_lshl_b32 s12, s5, 2
    s_add_u32 s12, s12, s7
    s_lshl_b32 s12, s12, 6
    s_add_u32 s11, s11, s12
    s_add_u32 s11, s11, 786432
    s_lshl_b32 s12, s4, 15
    s_add_u32 s12, s12, s11
    s_add_u32 s13, s11, 262144
    v_lshlrev_b32 v6, 2, v1
    s_waitcnt vmcnt(0) lgkmcnt(0)
    s_barrier
    ds_read2st64_b32 v[112:113], v6 offset0:0 offset1:1
    ds_read2st64_b32 v[114:115], v6 offset0:2 offset1:3
    ds_read2st64_b32 v[116:117], v6 offset0:4 offset1:5
    ds_read2st64_b32 v[118:119], v6 offset0:6 offset1:7
    ds_read2st64_b32 v[120:121], v6 offset0:8 offset1:9
    ds_read2st64_b32 v[122:123], v6 offset0:10 offset1:11
    ds_read2st64_b32 v[124:125], v6 offset0:12 offset1:13
    ds_read2st64_b32 v[126:127], v6 offset0:14 offset1:15
    s_waitcnt lgkmcnt(6)
    v_pk_add_f32 v[112:113], v[112:113], v[114:115]
    s_waitcnt lgkmcnt(4)
    v_pk_add_f32 v[116:117], v[116:117], v[118:119]
    s_waitcnt lgkmcnt(2)
    v_pk_add_f32 v[120:121], v[120:121], v[122:123]
    s_waitcnt lgkmcnt(0)
    v_pk_add_f32 v[124:125], v[124:125], v[126:127]
    v_pk_add_f32 v[112:113], v[112:113], v[116:117]
    v_pk_add_f32 v[120:121], v[120:121], v[124:125]
    v_pk_add_f32 v[112:113], v[112:113], v[120:121]
    v_add_f32 v16, v112, v113
    v_cvt_pk_bf16_f32 v16, v16, v16
    s_cmp_eq_u32 s4, 0
    s_cbranch_scc1 Lwo0
    v_mov_b32_dpp v20, v16 row_newbcast:0 row_mask:0xf bank_mask:0x3
    s_nop 1
    v_mov_b32_dpp v20, v16 row_newbcast:1 row_mask:0xf bank_mask:0xc
    v_and_b32 v112, v20, v12
    v_and_b32 v113, v20, v13
    v_and_b32 v114, v20, v14
    v_and_b32 v115, v20, v15
    s_nop 1
    v_mfma_f32_16x16x32_bf16 v[120:123], v[112:115], v[32:35], 0
    v_mov_b32_dpp v21, v16 row_newbcast:2 row_mask:0xf bank_mask:0x3
    s_nop 1
    v_mov_b32_dpp v21, v16 row_newbcast:3 row_mask:0xf bank_mask:0xc
    v_and_b32 v116, v21, v12
    v_and_b32 v117, v21, v13
    v_and_b32 v118, v21, v14
    v_and_b32 v119, v21, v15
    s_nop 1
    v_mfma_f32_16x16x32_bf16 v[120:123], v[116:119], v[36:39], v[120:123]
    v_mov_b32_dpp v20, v16 row_newbcast:4 row_mask:0xf bank_mask:0x3
    s_nop 1
    v_mov_b32_dpp v20, v16 row_newbcast:5 row_mask:0xf bank_mask:0xc
    v_and_b32 v112, v20, v12
    v_and_b32 v113, v20, v13
    v_and_b32 v114, v20, v14
    v_and_b32 v115, v20, v15
    s_nop 1
    v_mfma_f32_16x16x32_bf16 v[120:123], v[112:115], v[40:43], v[120:123]
    v_mov_b32_dpp v21, v16 row_newbcast:6 row_mask:0xf bank_mask:0x3
    s_nop 1
    v_mov_b32_dpp v21, v16 row_newbcast:7 row_mask:0xf bank_mask:0xc
    v_and_b32 v116, v21, v12
    v_and_b32 v117, v21, v13
    v_and_b32 v118, v21, v14
    v_and_b32 v119, v21, v15
    s_nop 1
    v_mfma_f32_16x16x32_bf16 v[120:123], v[116:119], v[44:47], v[120:123]
    v_mov_b32_dpp v20, v16 row_newbcast:8 row_mask:0xf bank_mask:0x3
    s_nop 1
    v_mov_b32_dpp v20, v16 row_newbcast:9 row_mask:0xf bank_mask:0xc
    v_and_b32 v112, v20, v12
    v_and_b32 v113, v20, v13
    v_and_b32 v114, v20, v14
    v_and_b32 v115, v20, v15
    s_nop 1
    v_mfma_f32_16x16x32_bf16 v[120:123], v[112:115], v[48:51], v[120:123]
    v_mov_b32_dpp v21, v16 row_newbcast:10 row_mask:0xf bank_mask:0x3
    s_nop 1
    v_mov_b32_dpp v21, v16 row_newbcast:11 row_mask:0xf bank_mask:0xc
    v_and_b32 v116, v21, v12
    v_and_b32 v117, v21, v13
    v_and_b32 v118, v21, v14
    v_and_b32 v119, v21, v15
    s_nop 1
    v_mfma_f32_16x16x32_bf16 v[120:123], v[116:119], v[52:55], v[120:123]
    v_mov_b32_dpp v20, v16 row_newbcast:12 row_mask:0xf bank_mask:0x3
    s_nop 1
    v_mov_b32_dpp v20, v16 row_newbcast:13 row_mask:0xf bank_mask:0xc
    v_and_b32 v112, v20, v12
    v_and_b32 v113, v20, v13
    v_and_b32 v114, v20, v14
    v_and_b32 v115, v20, v15
    s_nop 1
    v_mfma_f32_16x16x32_bf16 v[120:123], v[112:115], v[56:59], v[120:123]
    v_mov_b32_dpp v21, v16 row_newbcast:14 row_mask:0xf bank_mask:0x3
    s_nop 1
    v_mov_b32_dpp v21, v16 row_newbcast:15 row_mask:0xf bank_mask:0xc
    v_and_b32 v116, v21, v12
    v_and_b32 v117, v21, v13
    v_and_b32 v118, v21, v14
    v_and_b32 v119, v21, v15
    s_nop 1
    v_mfma_f32_16x16x32_bf16 v[120:123], v[116:119], v[60:63], v[120:123]
    s_nop 7
    v_permlane32_swap_b32 v120, v8
    v_permlane32_swap_b32 v121, v9
    v_permlane32_swap_b32 v122, v10
    v_permlane32_swap_b32 v123, v11
    v_add_f32_dpp v120, v8, v120 row_ror:8 row_mask:0xf bank_mask:0xf
    v_add_f32_dpp v121, v9, v121 row_ror:8 row_mask:0xf bank_mask:0xf
    v_add_f32_dpp v122, v10, v122 row_ror:8 row_mask:0xf bank_mask:0xf
    v_add_f32_dpp v123, v11, v123 row_ror:8 row_mask:0xf bank_mask:0xf
    v_bfi_b32 v120, s96, v0, v120
    v_bfi_b32 v121, s96, v0, v121
    v_bfi_b32 v122, s96, v0, v122
    v_bfi_b32 v123, s96, v0, v123
    buffer_store_dwordx4 v[120:123], v106, s[44:47], s12 offen sc1
    s_branch Lwod
Lwo0:
    v_mov_b32_dpp v20, v16 row_newbcast:0 row_mask:0xf bank_mask:0x3
    s_nop 1
    v_mov_b32_dpp v20, v16 row_newbcast:1 row_mask:0xf bank_mask:0xc
    v_and_b32 v112, v20, v12
    v_and_b32 v113, v20, v13
    v_and_b32 v114, v20, v14
    v_and_b32 v115, v20, v15
    s_nop 1
    v_mfma_f32_16x16x32_bf16 v[120:123], v[112:115], v[32:35], 0
    v_mfma_f32_16x16x32_bf16 v[124:127], v[112:115], v[64:67], 0
    v_mov_b32_dpp v21, v16 row_newbcast:2 row_mask:0xf bank_mask:0x3
    s_nop 1
    v_mov_b32_dpp v21, v16 row_newbcast:3 row_mask:0xf bank_mask:0xc
    v_and_b32 v116, v21, v12
    v_and_b32 v117, v21, v13
    v_and_b32 v118, v21, v14
    v_and_b32 v119, v21, v15
    s_nop 1
    v_mfma_f32_16x16x32_bf16 v[120:123], v[116:119], v[36:39], v[120:123]
    v_mfma_f32_16x16x32_bf16 v[124:127], v[116:119], v[68:71], v[124:127]
    v_mov_b32_dpp v20, v16 row_newbcast:4 row_mask:0xf bank_mask:0x3
    s_nop 1
    v_mov_b32_dpp v20, v16 row_newbcast:5 row_mask:0xf bank_mask:0xc
    v_and_b32 v112, v20, v12
    v_and_b32 v113, v20, v13
    v_and_b32 v114, v20, v14
    v_and_b32 v115, v20, v15
    s_nop 1
    v_mfma_f32_16x16x32_bf16 v[120:123], v[112:115], v[40:43], v[120:123]
    v_mfma_f32_16x16x32_bf16 v[124:127], v[112:115], v[72:75], v[124:127]
    v_mov_b32_dpp v21, v16 row_newbcast:6 row_mask:0xf bank_mask:0x3
    s_nop 1
    v_mov_b32_dpp v21, v16 row_newbcast:7 row_mask:0xf bank_mask:0xc
    v_and_b32 v116, v21, v12
    v_and_b32 v117, v21, v13
    v_and_b32 v118, v21, v14
    v_and_b32 v119, v21, v15
    s_nop 1
    v_mfma_f32_16x16x32_bf16 v[120:123], v[116:119], v[44:47], v[120:123]
    v_mfma_f32_16x16x32_bf16 v[124:127], v[116:119], v[76:79], v[124:127]
    v_mov_b32_dpp v20, v16 row_newbcast:8 row_mask:0xf bank_mask:0x3
    s_nop 1
    v_mov_b32_dpp v20, v16 row_newbcast:9 row_mask:0xf bank_mask:0xc
    v_and_b32 v112, v20, v12
    v_and_b32 v113, v20, v13
    v_and_b32 v114, v20, v14
    v_and_b32 v115, v20, v15
    s_nop 1
    v_mfma_f32_16x16x32_bf16 v[120:123], v[112:115], v[48:51], v[120:123]
    v_mfma_f32_16x16x32_bf16 v[124:127], v[112:115], v[80:83], v[124:127]
    v_mov_b32_dpp v21, v16 row_newbcast:10 row_mask:0xf bank_mask:0x3
    s_nop 1
    v_mov_b32_dpp v21, v16 row_newbcast:11 row_mask:0xf bank_mask:0xc
    v_and_b32 v116, v21, v12
    v_and_b32 v117, v21, v13
    v_and_b32 v118, v21, v14
    v_and_b32 v119, v21, v15
    s_nop 1
    v_mfma_f32_16x16x32_bf16 v[120:123], v[116:119], v[52:55], v[120:123]
    v_mfma_f32_16x16x32_bf16 v[124:127], v[116:119], v[84:87], v[124:127]
    v_mov_b32_dpp v20, v16 row_newbcast:12 row_mask:0xf bank_mask:0x3
    s_nop 1
    v_mov_b32_dpp v20, v16 row_newbcast:13 row_mask:0xf bank_mask:0xc
    v_and_b32 v112, v20, v12
    v_and_b32 v113, v20, v13
    v_and_b32 v114, v20, v14
    v_and_b32 v115, v20, v15
    s_nop 1
    v_mfma_f32_16x16x32_bf16 v[120:123], v[112:115], v[56:59], v[120:123]
    v_mfma_f32_16x16x32_bf16 v[124:127], v[112:115], v[88:91], v[124:127]
    v_mov_b32_dpp v21, v16 row_newbcast:14 row_mask:0xf bank_mask:0x3
    s_nop 1
    v_mov_b32_dpp v21, v16 row_newbcast:15 row_mask:0xf bank_mask:0xc
    v_and_b32 v116, v21, v12
    v_and_b32 v117, v21, v13
    v_and_b32 v118, v21, v14
    v_and_b32 v119, v21, v15
    s_nop 1
    v_mfma_f32_16x16x32_bf16 v[120:123], v[116:119], v[60:63], v[120:123]
    v_mfma_f32_16x16x32_bf16 v[124:127], v[116:119], v[92:95], v[124:127]
    s_nop 6
    v_permlane32_swap_b32 v120, v8
    v_permlane32_swap_b32 v121, v9
    v_permlane32_swap_b32 v122, v10
    v_permlane32_swap_b32 v123, v11
    v_add_f32_dpp v120, v8, v120 row_ror:8 row_mask:0xf bank_mask:0xf
    v_add_f32_dpp v121, v9, v121 row_ror:8 row_mask:0xf bank_mask:0xf
    v_add_f32_dpp v122, v10, v122 row_ror:8 row_mask:0xf bank_mask:0xf
    v_add_f32_dpp v123, v11, v123 row_ror:8 row_mask:0xf bank_mask:0xf
    v_bfi_b32 v120, s96, v0, v120
    v_bfi_b32 v121, s96, v0, v121
    v_bfi_b32 v122, s96, v0, v122
    v_bfi_b32 v123, s96, v0, v123
    buffer_store_dwordx4 v[120:123], v106, s[44:47], s12 offen sc1
    v_permlane32_swap_b32 v124, v16
    v_permlane32_swap_b32 v125, v17
    v_permlane32_swap_b32 v126, v18
    v_permlane32_swap_b32 v127, v19
    v_add_f32_dpp v124, v16, v124 row_ror:8 row_mask:0xf bank_mask:0xf
    v_add_f32_dpp v125, v17, v125 row_ror:8 row_mask:0xf bank_mask:0xf
    v_add_f32_dpp v126, v18, v126 row_ror:8 row_mask:0xf bank_mask:0xf
    v_add_f32_dpp v127, v19, v127 row_ror:8 row_mask:0xf bank_mask:0xf
    v_bfi_b32 v124, s96, v0, v124
    v_bfi_b32 v125, s96, v0, v125
    v_bfi_b32 v126, s96, v0, v126
    v_bfi_b32 v127, s96, v0, v127
    buffer_store_dwordx4 v[124:127], v106, s[44:47], s13 offen sc1
Lwod:
    s_cmp_eq_u32 s69, 1
    s_cbranch_scc1 Lffn
    s_cmp_eq_u32 s69, 2
    s_cbranch_scc1 Lred
    s_branch Lfin
Lred:
    s_mov_b32 s48, s38
    s_and_b32 s49, s39, 0xffff
    s_mov_b32 s50, 2304
    s_mov_b32 s51, 0x20000
    v_lshlrev_b32 v6, 4, v1
    s_lshl_b32 s12, s68, 13
    s_lshl_b32 s11, s4, 10
    s_add_u32 s12, s12, s11
    s_add_u32 s12, s12, 786432
    s_mul_i32 s13, s68, 9216
    s_add_u32 s13, s13, s11
    s_add_u32 s13, s13, 1376256
    s_add_u32 s14, s13, 8192
    s_cmp_eq_u32 s4, 0
    s_cselect_b32 s14, s14, 1073741824
    v_and_b32 v7, 12, v1
    v_cmp_eq_u32 vcc, 0, v7
    v_and_b32 v7, 3, v1
    v_lshlrev_b32 v7, 4, v7
    v_lshl_add_u32 v7, v3, 6, v7
    s_lshl_b32 s11, s4, 8
    s_add_u32 s11, s11, 4096
    v_add_u32 v7, s11, v7
    v_add_u32 v8, 10880, v6
    v_cndmask_b32 v7, v8, v7, vcc
    v_lshlrev_b32 v9, 2, v2
    v_lshl_add_u32 v9, v3, 9, v9
    v_add_u32 v9, 4096, v9
Lpx_64:
    buffer_load_dwordx4 v[32:35], v6, s[44:47], s12 offen sc1
    s_waitcnt vmcnt(0)
    v_xor_b32 v8, v32, v0
    v_bitop3_b32 v8, v8, v33, v0 bitop3:0xf6
    v_bitop3_b32 v8, v8, v34, v0 bitop3:0xf6
    v_bitop3_b32 v8, v8, v35, v0 bitop3:0xf6
    v_and_b32 v8, s96, v8
    v_cmp_ne_u32 vcc, 0, v8
    s_nop 0
    s_and_b64 exec, vcc, vcc
    s_cbranch_scc0 Lpxd_65
    s_sub_u32 s70, s70, 1
    s_cmp_gt_i32 s70, 0
    s_cbranch_scc1 Lpx_64
Lpxd_65:
    s_mov_b64 exec, -1
    v_and_b32 v32, s98, v32
    v_and_b32 v33, s98, v33
    v_and_b32 v34, s98, v34
    v_and_b32 v35, s98, v35
    v_add_f32_dpp v32, v32, v32 row_ror:8 row_mask:0xf bank_mask:0xf
    v_add_f32_dpp v33, v33, v33 row_ror:8 row_mask:0xf bank_mask:0xf
    v_add_f32_dpp v34, v34, v34 row_ror:8 row_mask:0xf bank_mask:0xf
    v_add_f32_dpp v35, v35, v35 row_ror:8 row_mask:0xf bank_mask:0xf
    v_add_f32_dpp v32, v32, v32 row_ror:4 row_mask:0xf bank_mask:0xf
    v_add_f32_dpp v33, v33, v33 row_ror:4 row_mask:0xf bank_mask:0xf
    v_add_f32_dpp v34, v34, v34 row_ror:4 row_mask:0xf bank_mask:0xf
    v_add_f32_dpp v35, v35, v35 row_ror:4 row_mask:0xf bank_mask:0xf
    ds_write_b128 v7, v[32:35]
    s_waitcnt lgkmcnt(0)
    s_barrier
    s_cmp_lg_u32 s4, 1
    s_cbranch_scc1 Lred2
    ds_read2_b32 v[40:41], v9 offset0:0 offset1:16
    ds_read2_b32 v[42:43], v9 offset0:32 offset1:48
    ds_read2_b32 v[44:45], v9 offset0:64 offset1:80
    ds_read2_b32 v[46:47], v9 offset0:96 offset1:112
    s_waitcnt lgkmcnt(2)
    v_pk_add_f32 v[40:41], v[40:41], v[42:43]
    s_waitcnt lgkmcnt(0)
    v_pk_add_f32 v[44:45], v[44:45], v[46:47]
    v_pk_add_f32 v[40:41], v[40:41], v[44:45]
    v_add_f32 v40, v40, v41
    v_mov_b32 v41, v40
    s_nop 1
    v_permlane16_swap_b32 v40, v41
    v_add_f32 v40, v40, v41
    v_mov_b32 v41, v40
    s_nop 1
    v_permlane32_swap_b32 v40, v41
    v_add_f32 v40, v40, v41
    v_fmac_f32 v107, v40, v108
    v_cvt_pk_bf16_f32 v107, v107, v107
    v_and_b32 v107, 0xffff0000, v107
    s_lshl_b32 s11, s68, 6
    s_add_u32 s11, s11, 2359296
    v_or_b32 v40, v107, v0
    buffer_store_dword v40, v111, s[44:47], s11 offen sc1
    s_add_u32 s11, s11, 18432
    buffer_store_dword v40, v111, s[44:47], s11 offen sc1
    s_add_u32 s11, s11, 18432
Lred2:
    s_cmp_eq_u32 s4, 0
    s_cbranch_scc1 Lred3
Lpx_66:
    buffer_load_dwordx4 v[32:35], v6, s[44:47], s13 offen sc1
    s_waitcnt vmcnt(0)
    v_xor_b32 v8, v32, v0
    v_bitop3_b32 v8, v8, v33, v0 bitop3:0xf6
    v_bitop3_b32 v8, v8, v34, v0 bitop3:0xf6
    v_bitop3_b32 v8, v8, v35, v0 bitop3:0xf6
    v_and_b32 v8, s96, v8
    v_cmp_ne_u32 vcc, 0, v8
    s_nop 0
    s_and_b64 exec, vcc, vcc
    s_cbranch_scc0 Lpxd_67
    s_sub_u32 s70, s70, 1
    s_cmp_gt_i32 s70, 0
    s_cbranch_scc1 Lpx_66
Lpxd_67:
    s_mov_b64 exec, -1
    v_and_b32 v32, s98, v32
    v_and_b32 v33, s98, v33
    v_and_b32 v34, s98, v34
    v_and_b32 v35, s98, v35
    s_branch Lred4
Lred3:
Lpx_68:
    buffer_load_dwordx4 v[32:35], v6, s[44:47], s13 offen sc1
    buffer_load_dwordx4 v[36:39], v6, s[44:47], s14 offen sc1
    s_waitcnt vmcnt(0)
    v_xor_b32 v8, v32, v0
    v_bitop3_b32 v8, v8, v33, v0 bitop3:0xf6
    v_bitop3_b32 v8, v8, v34, v0 bitop3:0xf6
    v_bitop3_b32 v8, v8, v35, v0 bitop3:0xf6
    v_bitop3_b32 v8, v8, v36, v0 bitop3:0xf6
    v_bitop3_b32 v8, v8, v37, v0 bitop3:0xf6
    v_bitop3_b32 v8, v8, v38, v0 bitop3:0xf6
    v_bitop3_b32 v8, v8, v39, v0 bitop3:0xf6
    v_and_b32 v8, s96, v8
    v_cmp_ne_u32 vcc, 0, v8
    s_nop 0
    s_and_b64 exec, vcc, vcc
    s_cbranch_scc0 Lpxd_69
    s_sub_u32 s70, s70, 1
    s_cmp_gt_i32 s70, 0
    s_cbranch_scc1 Lpx_68
Lpxd_69:
    s_mov_b64 exec, -1
    v_and_b32 v32, s98, v32
    v_and_b32 v33, s98, v33
    v_and_b32 v34, s98, v34
    v_and_b32 v35, s98, v35
    v_and_b32 v36, s98, v36
    v_and_b32 v37, s98, v37
    v_and_b32 v38, s98, v38
    v_and_b32 v39, s98, v39
    v_pk_add_f32 v[32:33], v[32:33], v[36:37]
    v_pk_add_f32 v[34:35], v[34:35], v[38:39]
Lred4:
    s_nop 0
    v_add_f32_dpp v32, v32, v32 row_ror:8 row_mask:0xf bank_mask:0xf
    v_add_f32_dpp v33, v33, v33 row_ror:8 row_mask:0xf bank_mask:0xf
    v_add_f32_dpp v34, v34, v34 row_ror:8 row_mask:0xf bank_mask:0xf
    v_add_f32_dpp v35, v35, v35 row_ror:8 row_mask:0xf bank_mask:0xf
    v_add_f32_dpp v32, v32, v32 row_ror:4 row_mask:0xf bank_mask:0xf
    v_add_f32_dpp v33, v33, v33 row_ror:4 row_mask:0xf bank_mask:0xf
    v_add_f32_dpp v34, v34, v34 row_ror:4 row_mask:0xf bank_mask:0xf
    v_add_f32_dpp v35, v35, v35 row_ror:4 row_mask:0xf bank_mask:0xf
    ds_write_b128 v7, v[32:35]
    s_waitcnt lgkmcnt(0)
    s_barrier
    s_cmp_lg_u32 s4, 1
    s_cbranch_scc1 Lfin
    ds_read2_b32 v[40:41], v9 offset0:0 offset1:16
    ds_read2_b32 v[42:43], v9 offset0:32 offset1:48
    ds_read2_b32 v[44:45], v9 offset0:64 offset1:80
    ds_read2_b32 v[46:47], v9 offset0:96 offset1:112
    s_waitcnt lgkmcnt(2)
    v_pk_add_f32 v[40:41], v[40:41], v[42:43]
    s_waitcnt lgkmcnt(0)
    v_pk_add_f32 v[44:45], v[44:45], v[46:47]
    v_pk_add_f32 v[40:41], v[40:41], v[44:45]
    v_add_f32 v40, v40, v41
    v_mov_b32 v41, v40
    s_nop 1
    v_permlane16_swap_b32 v40, v41
    v_add_f32 v40, v40, v41
    v_mov_b32 v41, v40
    s_nop 1
    v_permlane32_swap_b32 v40, v41
    v_add_f32 v40, v40, v41
    v_fma_f32 v40, v40, v109, v107
    v_cvt_pk_bf16_f32 v40, v40, v40
    buffer_store_short v40, v110, s[48:51], 0 offen
    s_cmp_lg_u32 s68, 0
    s_cbranch_scc1 Lfin
    v_mov_b32 v41, s97
    s_mov_b32 s11, 2068480
    s_mov_b64 exec, 1
    buffer_store_dword v41, v5, s[44:47], s11 offen sc1
    s_mov_b64 exec, -1
    s_branch Lfin
Lffn:
    v_lshrrev_b32 v6, 2, v2
    v_lshl_add_u32 v6, v3, 3, v6
    v_lshlrev_b32 v6, 6, v6
    v_and_b32 v7, 3, v1
    v_lshl_add_u32 v6, v7, 3, v6
    s_bfe_u32 s11, s4, 0x10001
    s_mul_i32 s11, s11, 36864
    s_and_b32 s12, s4, 1
    s_lshl_b32 s12, s12, 5
    s_add_u32 s11, s11, s12
    s_lshr_b32 s12, s4, 2
    s_mul_i32 s13, s12, 18432
    s_add_u32 s11, s11, s13
    s_add_u32 s11, s11, 12288
    v_add_u32 v6, s11, v6
    ds_read_b64_tr_b16 v[32:33], v6 offset:0
    ds_read_b64_tr_b16 v[34:35], v6 offset:256
    ds_read_b64_tr_b16 v[36:37], v6 offset:2048
    ds_read_b64_tr_b16 v[38:39], v6 offset:2304
    ds_read_b64_tr_b16 v[40:41], v6 offset:4096
    ds_read_b64_tr_b16 v[42:43], v6 offset:4352
    ds_read_b64_tr_b16 v[44:45], v6 offset:6144
    ds_read_b64_tr_b16 v[46:47], v6 offset:6400
    ds_read_b64_tr_b16 v[48:49], v6 offset:8192
    ds_read_b64_tr_b16 v[50:51], v6 offset:8448
    ds_read_b64_tr_b16 v[52:53], v6 offset:10240
    ds_read_b64_tr_b16 v[54:55], v6 offset:10496
    ds_read_b64_tr_b16 v[56:57], v6 offset:12288
    ds_read_b64_tr_b16 v[58:59], v6 offset:12544
    ds_read_b64_tr_b16 v[60:61], v6 offset:14336
    ds_read_b64_tr_b16 v[62:63], v6 offset:14592
    ds_read_b64_tr_b16 v[64:65], v6 offset:16384
    ds_read_b64_tr_b16 v[66:67], v6 offset:16640
    v_and_b32 v7, 1, v1
    v_mul_u32_u24 v7, 1152, v7
    v_lshl_add_u32 v7, v3, 4, v7
    s_mul_i32 s13, s12, 576
    s_add_u32 s13, s13, 7552
    v_add_u32 v104, s13, v7
    s_mul_i32 s13, s4, 288
    s_add_u32 s13, s13, 7552
    v_lshl_add_u32 v7, v1, 3, s13
    v_lshlrev_b32 v8, 3, v1
    v_add_u32 v8, 10880, v8
    v_cmp_gt_u32 s[14:15], 36, v1
    s_nop 1
    v_cndmask_b32 v105, v8, v7, s[14:15]
    s_lshl_b32 s13, s4, 7
    s_add_u32 s13, s13, 9856
    v_lshlrev_b32 v7, 6, v2
    v_lshl_add_u32 v7, v3, 4, v7
    v_add_u32 v7, s13, v7
    v_lshlrev_b32 v8, 4, v1
    v_add_u32 v8, 10880, v8
    v_cmp_gt_u32 vcc, 2, v2
    s_nop 1
    v_cndmask_b32 v107, v8, v7, vcc
    v_and_b32 v7, 7, v2
    v_lshl_add_u32 v7, v7, 2, v3
    v_lshrrev_b32 v8, 4, v7
    v_and_b32 v7, 15, v7
    v_lshlrev_b32 v7, 2, v7
    v_lshl_add_u32 v7, v8, 7, v7
    v_lshrrev_b32 v8, 3, v2
    v_lshl_add_u32 v7, v8, 6, v7
    v_add_u32 v108, 9856, v7
    s_lshl_b32 s13, s4, 3
    s_add_u32 s13, s13, 7424
    v_mov_b32 v109, s13
    s_lshl_b32 s13, s12, 5
    s_add_u32 s13, s13, 7424
    v_mov_b32 v9, s13
    s_and_b32 s12, s8, 0
    s_mul_i32 s13, s9, 1
    s_add_u32 s12, s12, s13
    s_mul_i32 s12, s12, 4608
    s_add_u32 s12, s12, 2359296
    s_mov_b64 exec, s[14:15]
Lpx_70:
    buffer_load_dwordx4 v[16:19], v111, s[44:47], s12 offen sc1
    s_waitcnt vmcnt(0)
    v_xor_b32 v8, v16, v0
    v_bitop3_b32 v8, v8, v17, v0 bitop3:0xf6
    v_bitop3_b32 v8, v8, v18, v0 bitop3:0xf6
    v_bitop3_b32 v8, v8, v19, v0 bitop3:0xf6
    v_and_b32 v8, s96, v8
    v_cmp_ne_u32 vcc, 0, v8
    s_nop 0
    s_and_b64 exec, vcc, vcc
    s_cbranch_scc0 Lpxd_71
    s_sub_u32 s70, s70, 1
    s_cmp_gt_i32 s70, 0
    s_cbranch_scc1 Lpx_70
Lpxd_71:
    s_mov_b64 exec, -1
    v_and_b32 v16, s98, v16
    v_and_b32 v17, s98, v17
    v_and_b32 v18, s98, v18
    v_and_b32 v19, s98, v19
    v_readfirstlane_b32 s11, v16
    s_nop 1
    v_subrev_f32 v20, s11, v16
    v_subrev_f32 v21, s11, v17
    v_subrev_f32 v22, s11, v18
    v_subrev_f32 v23, s11, v19
    v_add_f32 v10, v20, v21
    v_mul_f32 v11, v20, v20
    v_add_f32 v10, v10, v22
    v_fmac_f32 v11, v21, v21
    v_add_f32 v10, v10, v23
    v_fmac_f32 v11, v22, v22
    v_fmac_f32 v11, v23, v23
    v_cndmask_b32 v10, 0, v10, s[14:15]
    v_cndmask_b32 v11, 0, v11, s[14:15]
    s_nop 0
    v_add_f32_dpp v10, v10, v10 row_ror:8 row_mask:0xf bank_mask:0xf
    v_add_f32_dpp v11, v11, v11 row_ror:8 row_mask:0xf bank_mask:0xf
    s_nop 0
    v_add_f32_dpp v10, v10, v10 row_ror:4 row_mask:0xf bank_mask:0xf
    v_add_f32_dpp v11, v11, v11 row_ror:4 row_mask:0xf bank_mask:0xf
    s_nop 0
    v_add_f32_dpp v10, v10, v10 row_ror:2 row_mask:0xf bank_mask:0xf
    v_add_f32_dpp v11, v11, v11 row_ror:2 row_mask:0xf bank_mask:0xf
    s_nop 0
    v_add_f32_dpp v10, v10, v10 row_ror:1 row_mask:0xf bank_mask:0xf
    v_add_f32_dpp v11, v11, v11 row_ror:1 row_mask:0xf bank_mask:0xf
    v_mov_b32 v20, v10
    v_mov_b32 v21, v11
    s_nop 0
    v_permlane16_swap_b32 v10, v20
    v_permlane16_swap_b32 v11, v21
    v_add_f32 v10, v10, v20
    v_add_f32 v11, v11, v21
    v_mov_b32 v20, v10
    v_mov_b32 v21, v11
    s_nop 0
    v_permlane32_swap_b32 v10, v20
    v_permlane32_swap_b32 v11, v21
    v_add_f32 v10, v10, v20
    v_add_f32 v11, v11, v21
    v_mul_f32 v20, 0x3be38e39, v10
    v_fma_f32 v11, -v20, v10, v11
    v_add_f32 v10, s11, v20
    ds_write_b64 v109, v[10:11]
    s_waitcnt lgkmcnt(0)
    s_barrier
    ds_read_b128 v[112:115], v9
    ds_read_b128 v[116:119], v9 offset:16
    s_waitcnt lgkmcnt(0)
    v_add_f32 v10, v112, v114
    v_add_f32 v11, v116, v118
    v_add_f32 v20, v113, v115
    v_add_f32 v21, v117, v119
    v_add_f32 v10, v10, v11
    v_add_f32 v11, v20, v21
    v_mul_f32 v10, 0x3e800000, v10
    v_sub_f32 v112, v112, v10
    v_sub_f32 v114, v114, v10
    v_sub_f32 v116, v116, v10
    v_sub_f32 v118, v118, v10
    v_mul_f32 v20, v112, v112
    v_fmac_f32 v20, v114, v114
    v_fmac_f32 v20, v116, v116
    v_fmac_f32 v20, v118, v118
    v_mul_f32 v11, 0x3ae38e39, v11
    v_fmac_f32 v11, 0x3e800000, v20
    v_add_f32 v11, 0x3727c5ac, v11
    v_rsq_f32 v11, v11
    v_sub_f32 v16, v16, v10
    v_sub_f32 v17, v17, v10
    v_sub_f32 v18, v18, v10
    v_sub_f32 v19, v19, v10
    v_mul_f32 v24, v24, v11
    v_mul_f32 v25, v25, v11
    v_mul_f32 v26, v26, v11
    v_mul_f32 v27, v27, v11
    v_fma_f32 v16, v16, v24, v28
    v_fma_f32 v17, v17, v25, v29
    v_fma_f32 v18, v18, v26, v30
    v_fma_f32 v19, v19, v27, v31
    v_cvt_pk_bf16_f32 v16, v16, v17
    v_cvt_pk_bf16_f32 v17, v18, v19
    ds_write_b64 v105, v[16:17]
    s_waitcnt lgkmcnt(0)
    s_barrier
    ds_read_b128 v[8:11], v104 offset:0
    ds_read_b128 v[16:19], v104 offset:64
    ds_read_b128 v[20:23], v104 offset:128
    ds_read_b128 v[24:27], v104 offset:192
    ds_read_b128 v[28:31], v104 offset:256
    ds_read_b128 v[68:71], v104 offset:320
    ds_read_b128 v[112:115], v104 offset:384
    ds_read_b128 v[116:119], v104 offset:448
    ds_read_b128 v[124:127], v104 offset:512
    s_waitcnt lgkmcnt(8)
    v_mfma_f32_16x16x32_bf16 v[120:123], v[32:35], v[8:11], 0
    s_waitcnt lgkmcnt(7)
    v_mfma_f32_16x16x32_bf16 v[120:123], v[36:39], v[16:19], v[120:123]
    s_waitcnt lgkmcnt(6)
    v_mfma_f32_16x16x32_bf16 v[120:123], v[40:43], v[20:23], v[120:123]
    s_waitcnt lgkmcnt(5)
    v_mfma_f32_16x16x32_bf16 v[120:123], v[44:47], v[24:27], v[120:123]
    s_waitcnt lgkmcnt(4)
    v_mfma_f32_16x16x32_bf16 v[120:123], v[48:51], v[28:31], v[120:123]
    s_waitcnt lgkmcnt(3)
    v_mfma_f32_16x16x32_bf16 v[120:123], v[52:55], v[68:71], v[120:123]
    s_waitcnt lgkmcnt(2)
    v_mfma_f32_16x16x32_bf16 v[120:123], v[56:59], v[112:115], v[120:123]
    s_waitcnt lgkmcnt(1)
    v_mfma_f32_16x16x32_bf16 v[120:123], v[60:63], v[116:119], v[120:123]
    s_waitcnt lgkmcnt(0)
    v_mfma_f32_16x16x32_bf16 v[120:123], v[64:67], v[124:127], v[120:123]
    s_nop 7
    ds_write_b128 v107, v[120:123]
    s_waitcnt lgkmcnt(0)
    s_barrier
    s_cmp_lt_u32 s4, 3
    s_cbranch_scc1 Lfin
    ds_read2st64_b32 v[16:17], v108 offset0:0 offset1:1
    ds_read2st64_b32 v[18:19], v108 offset0:2 offset1:3
    s_waitcnt lgkmcnt(0)
    v_pk_add_f32 v[16:17], v[16:17], v[18:19]
    v_mul_f32 v18, v16, v16
    v_mov_b32 v19, 0xc0135761
    v_fmac_f32 v19, 0xbdd2d3e8, v18
    v_mul_f32 v18, v16, v19
    v_exp_f32 v18, v18
    s_nop 0
    v_add_f32 v18, 1.0, v18
    v_rcp_f32 v18, v18
    s_nop 0
    v_mul_f32 v16, v16, v18
    v_mul_f32 v16, v16, v17
    v_cvt_pk_bf16_f32 v16, v16, v16
    s_nop 1
    v_mov_b32_dpp v20, v16 row_newbcast:0 row_mask:0xf bank_mask:0x3
    s_nop 1
    v_mov_b32_dpp v20, v16 row_newbcast:8 row_mask:0xf bank_mask:0xc
    v_and_b32 v112, v20, v12
    v_and_b32 v113, v20, v13
    v_and_b32 v114, v20, v14
    v_and_b32 v115, v20, v15
    s_nop 1
    v_mfma_f32_16x16x32_bf16 v[120:123], v[112:115], v[72:75], 0
    v_mov_b32_dpp v21, v16 row_newbcast:1 row_mask:0xf bank_mask:0x3
    s_nop 1
    v_mov_b32_dpp v21, v16 row_newbcast:9 row_mask:0xf bank_mask:0xc
    v_and_b32 v116, v21, v12
    v_and_b32 v117, v21, v13
    v_and_b32 v118, v21, v14
    v_and_b32 v119, v21, v15
    s_nop 1
    v_mfma_f32_16x16x32_bf16 v[120:123], v[116:119], v[76:79], v[120:123]
    v_mov_b32_dpp v20, v16 row_newbcast:2 row_mask:0xf bank_mask:0x3
    s_nop 1
    v_mov_b32_dpp v20, v16 row_newbcast:10 row_mask:0xf bank_mask:0xc
    v_and_b32 v112, v20, v12
    v_and_b32 v113, v20, v13
    v_and_b32 v114, v20, v14
    v_and_b32 v115, v20, v15
    s_nop 1
    v_mfma_f32_16x16x32_bf16 v[120:123], v[112:115], v[80:83], v[120:123]
    v_mov_b32_dpp v21, v16 row_newbcast:3 row_mask:0xf bank_mask:0x3
    s_nop 1
    v_mov_b32_dpp v21, v16 row_newbcast:11 row_mask:0xf bank_mask:0xc
    v_and_b32 v116, v21, v12
    v_and_b32 v117, v21, v13
    v_and_b32 v118, v21, v14
    v_and_b32 v119, v21, v15
    s_nop 1
    v_mfma_f32_16x16x32_bf16 v[120:123], v[116:119], v[84:87], v[120:123]
    v_mov_b32_dpp v20, v16 row_newbcast:4 row_mask:0xf bank_mask:0x3
    s_nop 1
    v_mov_b32_dpp v20, v16 row_newbcast:12 row_mask:0xf bank_mask:0xc
    v_and_b32 v112, v20, v12
    v_and_b32 v113, v20, v13
    v_and_b32 v114, v20, v14
    v_and_b32 v115, v20, v15
    s_nop 1
    v_mfma_f32_16x16x32_bf16 v[120:123], v[112:115], v[88:91], v[120:123]
    v_mov_b32_dpp v21, v16 row_newbcast:5 row_mask:0xf bank_mask:0x3
    s_nop 1
    v_mov_b32_dpp v21, v16 row_newbcast:13 row_mask:0xf bank_mask:0xc
    v_and_b32 v116, v21, v12
    v_and_b32 v117, v21, v13
    v_and_b32 v118, v21, v14
    v_and_b32 v119, v21, v15
    s_nop 1
    v_mfma_f32_16x16x32_bf16 v[120:123], v[116:119], v[92:95], v[120:123]
    v_mov_b32_dpp v20, v16 row_newbcast:6 row_mask:0xf bank_mask:0x3
    s_nop 1
    v_mov_b32_dpp v20, v16 row_newbcast:14 row_mask:0xf bank_mask:0xc
    v_and_b32 v112, v20, v12
    v_and_b32 v113, v20, v13
    v_and_b32 v114, v20, v14
    v_and_b32 v115, v20, v15
    s_nop 1
    v_mfma_f32_16x16x32_bf16 v[120:123], v[112:115], v[96:99], v[120:123]
    v_mov_b32_dpp v21, v16 row_newbcast:7 row_mask:0xf bank_mask:0x3
    s_nop 1
    v_mov_b32_dpp v21, v16 row_newbcast:15 row_mask:0xf bank_mask:0xc
    v_and_b32 v116, v21, v12
    v_and_b32 v117, v21, v13
    v_and_b32 v118, v21, v14
    v_and_b32 v119, v21, v15
    s_nop 1
    v_mfma_f32_16x16x32_bf16 v[120:123], v[116:119], v[100:103], v[120:123]
    s_nop 7
    v_bfi_b32 v120, s96, v0, v120
    v_bfi_b32 v121, s96, v0, v121
    v_bfi_b32 v122, s96, v0, v122
    v_bfi_b32 v123, s96, v0, v123
    buffer_store_dwordx4 v[120:123], v110, s[44:47], 0 offen sc1
Lfin:
Lend:
    s_endpgm
.section .rodata,"a"
.p2align 6
.amdhsa_kernel adaLN_cond__mha_block_cached__geglu_ffn__decode_kernel
  .amdhsa_next_free_vgpr 128
  .amdhsa_next_free_sgpr 102
  .amdhsa_accum_offset 128
  .amdhsa_group_segment_fixed_size 0
  .amdhsa_kernarg_size 112
  .amdhsa_user_sgpr_count 2
  .amdhsa_user_sgpr_kernarg_segment_ptr 1
  .amdhsa_system_sgpr_workgroup_id_x 1
.end_amdhsa_kernel
```
